```python
import torch

def _softmax(x, axis=-1):
    return torch.softmax(x, dim=axis)
def _gelu(x):
    return torch.nn.functional.gelu(x, approximate="tanh")
def _silu(x):
    return torch.nn.functional.silu(x)
def _sigmoid(x):
    return torch.sigmoid(x)
def _layernorm(x, axis=-1, eps=1e-5):
    m = x.mean(dim=axis, keepdim=True)
    v = x.var(dim=axis, keepdim=True, unbiased=False)
    return (x - m) / torch.sqrt(v + eps)
def _scatter_add(tgt, idx, src, axis=0):
    return tgt.clone().index_add_(axis, idx, src)
def _segment_sum(src, seg, n):
    out = torch.zeros((n,) + src.shape[1:], dtype=src.dtype)
    return out.index_add_(0, seg, src)
def _pad(x, pw):
    flat = tuple(v for pair in reversed(pw) for v in pair)
    return torch.nn.functional.pad(x, flat)

kernel_name = 'parallel_sum__mha_block__glu_gated_reglu__prompt'

def setup_inputs():

    _w = (lambda a: (lambda t: t.to(torch.bfloat16) if t.is_floating_point() else t)(torch.as_tensor(a)))
    def _A_setup():
        B, S, D, H = 1, 2048, 512, 32
        return {
            "x": _w((lambda *s: torch.randn(*s, dtype=torch.bfloat16) * 0.05)(B, S, D)),
            "wqkv": _w((lambda *s: torch.randn(*s, dtype=torch.bfloat16) * 0.05)(D, 3 * D)),
            "wo": _w((lambda *s: torch.randn(*s, dtype=torch.bfloat16) * 0.05)(D, D)),
        }
    _A_in = _A_setup()

    def _B_setup():
        B, S, D, F = 1, 2048, 512, 1792
        return {
            "x": _w((lambda *s: torch.randn(*s, dtype=torch.bfloat16) * 0.05)(B, S, D)),
            "W_gate": _w((lambda *s: torch.randn(*s, dtype=torch.bfloat16) * 0.4)(D, F) * (2.0 / D) ** 0.5),
            "W_up": _w((lambda *s: torch.randn(*s, dtype=torch.bfloat16) * 0.4)(D, F) * (2.0 / D) ** 0.5),
            "W_down": _w((lambda *s: torch.randn(*s, dtype=torch.bfloat16) * 0.4)(F, D) * (1.0 / F) ** 0.5),
        }
    _B_in = _B_setup()

    return {
        "A_x": _A_in["x"],
        "A_wqkv": _A_in["wqkv"],
        "A_wo": _A_in["wo"],
        "B_x": _B_in["x"],
        "B_W_gate": _B_in["W_gate"],
        "B_W_up": _B_in["W_up"],
        "B_W_down": _B_in["W_down"],
    }

def reference(A_x, A_wqkv, A_wo, B_x, B_W_gate, B_W_up, B_W_down):
    def _A_ref(x, wqkv, wo):
        B, S, D = x.shape
        H = 32
        Dh = D // H
        qkv = (lambda x, *d: x.permute(*d))((x @ wqkv).reshape(B, S, 3, H, Dh), 2, 0, 3, 1, 4)
        q, k, v = qkv[0], qkv[1], qkv[2]
        scores = torch.einsum("bhqd,bhkd->bhqk", q, k) * (Dh ** -0.5)
        p = _softmax(scores, axis=-1)
        o = torch.einsum("bhqk,bhkd->bhqd", p, v)
        return (lambda x, *d: x.permute(*d))(o, 0, 2, 1, 3).reshape(B, S, D) @ wo

    def _B_ref(x, W_gate, W_up, W_down):
        gate = torch.einsum("bsd,df->bsf", x, W_gate)
        up = torch.einsum("bsd,df->bsf", x, W_up)
        gate = gate * (lambda x, dt: x.to(dt))(gate > 0, gate.dtype)
        h = gate * up
        return torch.einsum("bsf,fd->bsd", h, W_down)

    x = A_x
    xn = _layernorm(x, axis=-1)
    return x + _A_ref(xn, A_wqkv, A_wo) + _B_ref(xn, B_W_gate, B_W_up, B_W_down)
```

```asm
; @launch grid=(512,1,1) block=(512,1,1) lds=81920
.amdgcn_target "amdgcn-amd-amdhsa--gfx950"
.text
.globl parallel_sum__mha_block__glu_gated_reglu__prompt_kernel
.p2align 8
.type parallel_sum__mha_block__glu_gated_reglu__prompt_kernel,@function
parallel_sum__mha_block__glu_gated_reglu__prompt_kernel:
    s_load_dwordx2 s[4:5], s[0:1], 0
    s_load_dwordx2 s[8:9], s[0:1], 8
    s_load_dwordx2 s[12:13], s[0:1], 72
    s_load_dwordx2 s[40:41], s[0:1], 64
    s_cmp_ge_u32 s2, 512
    s_cbranch_scc1 L_exit
    v_lshrrev_b32 v1, 6, v0
    s_nop 0
    v_readfirstlane_b32 s16, v1
    v_and_b32 v0, 63, v0
    s_and_b32 s54, s2, 7
    s_bfe_u32 s55, s2, 0x50003
    s_lshr_b32 s17, s54, 1
    s_lshl_b32 s17, s17, 2
    s_and_b32 s18, s55, 3
    s_add_u32 s17, s17, s18
    s_lshr_b32 s55, s55, 2
    s_and_b32 s54, s54, 1
    s_lshl_b32 s18, s54, 3
    s_add_u32 s18, s18, s55
    s_cmp_ge_u32 s2, 256
    s_mov_b32 s6, 2097152
    s_mov_b32 s7, 0x00020000
    s_mov_b32 s10, 1572864
    s_mov_b32 s11, 0x00020000
    s_mov_b32 s14, 17825792
    s_mov_b32 s15, 0x00020000
    s_mov_b32 s42, 256
    s_mov_b32 s43, 0x00020000
    s_cbranch_scc0 L_role_a
    s_setprio 3
    v_lshlrev_b32 v18, 4, v0
    s_lshl_b32 s20, s17, 4
    s_add_u32 s20, s20, s18
    s_lshl_b32 s20, s20, 3
    s_add_u32 s20, s20, s16
    s_lshl_b32 s20, s20, 10
    v_min_u32 v1, 5, v0
    v_lshlrev_b32 v1, 10, v1
    s_and_b32 s24, s2, 0xf8
    s_add_u32 s24, s24, s16
    s_mul_i32 s24, s24, 6144
    s_lshl_b32 s25, s54, 21
    s_add_u32 s24, s24, s25
    s_add_u32 s24, s24, 384
    s_waitcnt lgkmcnt(0)
    buffer_load_dwordx4 v[20:23], v18, s[4:7], s20 offen
    s_branch L_role_f
L_role_a:
    s_xor_b32 s26, s16, 7
    s_or_b32 s26, s26, s2
    s_cbranch_scc1 L_nonw
    s_setprio 3
    s_memrealtime s[26:27]
    s_waitcnt lgkmcnt(0)
    s_or_b32 s26, s26, 1
    v_mov_b32 v14, s26
    buffer_store_dword v14, off, s[40:43], 0 sc0 sc1
L_nonw:
    s_and_b32 s35, s16, 3
    v_lshrrev_b32 v1, 3, v0
    s_lshl_b32 s24, s16, 4
    v_add_u32 v1, s24, v1
    v_lshlrev_b32 v1, 10, v1
    v_lshrrev_b32 v10, 4, v0
    v_xor_b32 v10, v10, v0
    v_and_b32 v10, 7, v10
    v_lshl_add_u32 v2, v10, 4, v1
    v_xor_b32 v126, 64, v2
    v_add_u32 v126, 8192, v126
    s_and_b32 s24, s35, 1
    s_add_u32 s25, s24, 4
    s_lshr_b32 s31, s35, 1
    s_cmp_ge_u32 s16, 4
    s_cselect_b32 s34, s35, s25
    s_cselect_b32 s31, 0, s31
    s_lshl_b32 s24, s24, 4
    s_lshl_b32 s25, s31, 5
    s_add_u32 s24, s24, s25
    v_lshrrev_b32 v1, 2, v0
    v_add_u32 v1, s24, v1
    v_mul_u32_u24 v10, 3072, v1
    v_and_b32 v1, 3, v0
    v_lshl_add_u32 v10, v1, 4, v10
    s_lshr_b32 s24, s34, 1
    s_lshl_b32 s24, s24, 4
    s_add_u32 s24, s24, s18
    s_lshl_b32 s24, s24, 6
    v_add_u32 v3, s24, v10
    s_lshl_b32 s34, s34, 10
    s_lshl_b32 s33, s16, 11
    s_lshl_b32 s20, s17, 17
    s_mov_b32 s21, 0
    s_lshl_b32 s24, s17, 1
    s_lshl_b32 s25, s18, 0
    s_add_u32 s24, s24, s25
    s_and_b32 s24, s24, 7
    s_mul_i32 s21, s24, 196608
    s_lshl_b32 s24, s24, 7
    s_add_u32 s20, s20, s24
    s_cmp_ge_u32 s16, 4
    s_cbranch_scc1 L_a_fl_v
    s_waitcnt lgkmcnt(0)
    s_mul_i32 s22, s31, 6144
    s_add_u32 s22, s22, 49152
    s_add_u32 m0, s34, s22
    s_nop 0
    buffer_load_dwordx4 v3, s[8:11], s21 offen lds
    s_add_u32 s21, s21, 196608
    s_cmp_eq_u32 s21, 1572864
    s_cselect_b32 s21, 0, s21
    s_add_u32 m0, s33, 0
    s_nop 0
    buffer_load_dwordx4 v2, s[4:7], s20 offen lds
    s_add_u32 m0, s33, 1024
    s_nop 0
    buffer_load_dwordx4 v126, s[4:7], s20 offen lds
    s_add_u32 s20, s20, 128
    s_bitset0_b32 s20, 10
    s_mul_i32 s22, s31, 6144
    s_add_u32 s22, s22, 61440
    s_add_u32 m0, s34, s22
    s_nop 0
    buffer_load_dwordx4 v3, s[8:11], s21 offen lds
    s_add_u32 s21, s21, 196608
    s_cmp_eq_u32 s21, 1572864
    s_cselect_b32 s21, 0, s21
    s_add_u32 m0, s33, 16384
    s_nop 0
    buffer_load_dwordx4 v2, s[4:7], s20 offen lds
    s_add_u32 m0, s33, 17408
    s_nop 0
    buffer_load_dwordx4 v126, s[4:7], s20 offen lds
    s_add_u32 s20, s20, 128
    s_bitset0_b32 s20, 10
    s_branch L_a_fl_d
L_a_fl_v:
    s_waitcnt lgkmcnt(0)
    s_add_u32 m0, s34, 49152
    s_add_u32 s22, s21, 98304
    buffer_load_dwordx4 v3, s[8:11], s21 offen lds
    s_add_u32 m0, s34, 55296
    s_add_u32 s21, s21, 196608
    buffer_load_dwordx4 v3, s[8:11], s22 offen lds
    s_cmp_eq_u32 s21, 1572864
    s_cselect_b32 s21, 0, s21
    s_add_u32 m0, s33, 0
    s_nop 0
    buffer_load_dwordx4 v2, s[4:7], s20 offen lds
    s_add_u32 m0, s33, 1024
    s_nop 0
    buffer_load_dwordx4 v126, s[4:7], s20 offen lds
    s_add_u32 s20, s20, 128
    s_bitset0_b32 s20, 10
    s_add_u32 m0, s34, 61440
    s_add_u32 s22, s21, 98304
    buffer_load_dwordx4 v3, s[8:11], s21 offen lds
    s_add_u32 m0, s34, 67584
    s_add_u32 s21, s21, 196608
    buffer_load_dwordx4 v3, s[8:11], s22 offen lds
    s_cmp_eq_u32 s21, 1572864
    s_cselect_b32 s21, 0, s21
    s_add_u32 m0, s33, 16384
    s_nop 0
    buffer_load_dwordx4 v2, s[4:7], s20 offen lds
    s_add_u32 m0, s33, 17408
    s_nop 0
    buffer_load_dwordx4 v126, s[4:7], s20 offen lds
    s_add_u32 s20, s20, 128
    s_bitset0_b32 s20, 10
L_a_fl_d:
    s_setprio 3
    s_lshl_b32 s25, s35, 12
    v_and_b32 v1, 31, v0
    v_lshlrev_b32 v1, 7, v1
    v_add_u32 v1, s25, v1
    v_bfe_u32 v10, v0, 1, 3
    v_lshrrev_b32 v11, 5, v0
    v_xor_b32 v10, v10, v11
    v_lshl_add_u32 v4, v10, 4, v1
    v_bfe_u32 v1, v0, 2, 2
    v_lshlrev_b32 v1, 6, v1
    v_bfe_u32 v10, v0, 4, 1
    v_lshl_add_u32 v1, v10, 5, v1
    v_and_b32 v10, 3, v0
    v_lshl_add_u32 v1, v10, 3, v1
    v_lshrrev_b32 v10, 5, v0
    v_lshl_add_u32 v1, v10, 9, v1
    v_add_u32 v6, 49152, v1
    v_lshlrev_b32 v44, 4, v0
    s_lshl_b32 s28, s17, 2
    s_add_u32 s28, s28, s35
    s_add_u32 s25, s28, 64
    s_cmp_ge_u32 s16, 4
    s_cselect_b32 s24, s25, s28
    s_lshl_b32 s29, s18, 8
    s_add_u32 s29, s29, s24
    s_lshl_b32 s29, s29, 10
    s_lshl_b32 s23, s28, 4
    s_add_u32 s23, s23, s18
    s_lshl_b32 s23, s23, 10
    s_add_u32 s23, s23, 16777216
    s_and_b32 s24, s16, 4
    s_xor_b32 s28, s28, s24
    s_mul_i32 s28, s28, 144
    s_lshl_b32 s24, s18, 1
    s_add_u32 s28, s28, s24
    s_and_b32 s30, s17, 1
    s_lshl_b32 s28, s28, 1
    s_add_u32 s28, s28, s30
    s_lshl_b32 s28, s28, 9
    s_add_u32 s28, s28, 6291456
    s_lshl_b32 s30, s30, 14
    v_mov_b32 v11, 0x3f803f80
    v_and_b32 v10, 15, v0
    v_bfe_u32 v47, v0, 4, 1
    v_cmp_eq_u32 vcc, v10, v47
    s_nop 1
    v_cndmask_b32 v52, 0, v11, vcc
    v_mov_b32 v53, v52
    v_mov_b32 v54, v52
    v_mov_b32 v55, v52
    s_and_b32 s25, s16, 1
    s_lshl_b32 s25, s25, 10
    s_add_u32 s25, s25, s30
    s_add_u32 s25, s25, 32768
    v_add_u32 v45, s25, v44
    v_lshrrev_b32 v1, 5, v0
    v_lshlrev_b32 v1, 8, v1
    v_lshl_add_u32 v16, v10, 4, v1
    s_add_u32 s24, s25, 8192
    v_add_u32 v1, s24, v1
    v_cmp_eq_u32 vcc, 0, v47
    v_mov_b32 v11, 65536
    s_nop 0
    v_cndmask_b32 v1, v11, v1, vcc
    v_lshl_add_u32 v46, v10, 4, v1
    v_lshrrev_b32 v1, 5, v0
    v_mul_u32_u24 v1, 384, v1
    v_and_b32 v11, 31, v0
    v_lshl_add_u32 v1, v11, 2, v1
    v_add_u32 v18, 80384, v1
    v_mov_b32 v50, 0
    v_mov_b32 v51, 0
    v_mov_b32 v98, 0
    v_mov_b32 v99, 0
    v_mov_b32 v56, 0
    v_mov_b32 v57, 0
    v_mov_b32 v58, 0
    v_mov_b32 v59, 0
    v_mov_b32 v60, 0
    v_mov_b32 v61, 0
    v_mov_b32 v62, 0
    v_mov_b32 v63, 0
    v_mov_b32 v64, 0
    v_mov_b32 v65, 0
    v_mov_b32 v66, 0
    v_mov_b32 v67, 0
    v_mov_b32 v68, 0
    v_mov_b32 v69, 0
    v_mov_b32 v70, 0
    v_mov_b32 v71, 0
    v_mov_b32 v72, 0
    v_mov_b32 v73, 0
    v_mov_b32 v74, 0
    v_mov_b32 v75, 0
    v_mov_b32 v76, 0
    v_mov_b32 v77, 0
    v_mov_b32 v78, 0
    v_mov_b32 v79, 0
    v_mov_b32 v80, 0
    v_mov_b32 v81, 0
    v_mov_b32 v82, 0
    v_mov_b32 v83, 0
    v_mov_b32 v84, 0
    v_mov_b32 v85, 0
    v_mov_b32 v86, 0
    v_mov_b32 v87, 0
    v_mov_b32 v88, 0
    v_mov_b32 v89, 0
    v_mov_b32 v90, 0
    v_mov_b32 v91, 0
    v_mov_b32 v92, 0
    v_mov_b32 v93, 0
    v_mov_b32 v94, 0
    v_mov_b32 v95, 0
    s_cmp_ge_u32 s16, 4
    s_cbranch_scc1 L_a_vloop
    s_lshl_b32 s24, s35, 10
    v_lshrrev_b32 v16, 1, v44
    v_xor_b32 v16, v16, v44
    v_and_b32 v16, 64, v16
    v_mul_u32_u24 v16, 3, v16
    v_xor_b32 v16, v16, v44
    v_add_u32 v17, s24, v16
    v_add_u32 v9, s24, v44
    v_xor_b32 v47, 1, v47
    v_xor_b32 v5, 32, v4
    v_xor_b32 v127, 64, v4
    v_xor_b32 v125, 96, v4
    s_waitcnt vmcnt(3) lgkmcnt(0)
    s_barrier
    ds_read_b128 v[20:23], v4 offset:0
    ds_read_b64_tr_b16 v[28:29], v6 offset:0
    ds_read_b64_tr_b16 v[30:31], v6 offset:256
    ds_read_b64_tr_b16 v[36:37], v6 offset:2048
    ds_read_b64_tr_b16 v[38:39], v6 offset:2304
    ds_read_b128 v[24:27], v5 offset:0
    ds_read_b64_tr_b16 v[32:33], v6 offset:1024
    ds_read_b64_tr_b16 v[34:35], v6 offset:1280
    ds_read_b64_tr_b16 v[40:41], v6 offset:3072
    ds_read_b64_tr_b16 v[42:43], v6 offset:3328
    s_add_u32 m0, s33, 32768
    s_nop 0
    buffer_load_dwordx4 v2, s[4:7], s20 offen lds
    s_add_u32 m0, s33, 33792
    s_nop 0
    buffer_load_dwordx4 v126, s[4:7], s20 offen lds
    s_add_u32 s20, s20, 128
    s_bitset0_b32 s20, 10
    s_waitcnt lgkmcnt(0)
    s_barrier
    v_mfma_f32_32x32x16_bf16 v[64:79], v[28:31], v[20:23], v[64:79]
    ds_read_b128 v[100:103], v127 offset:0
    ds_read_b64_tr_b16 v[108:109], v6 offset:6144
    ds_read_b64_tr_b16 v[110:111], v6 offset:6400
    ds_read_b64_tr_b16 v[116:117], v6 offset:8192
    v_mfma_f32_32x32x16_bf16 v[80:95], v[36:39], v[20:23], v[80:95]
    ds_read_b64_tr_b16 v[118:119], v6 offset:8448
    ds_read_b128 v[104:107], v125 offset:0
    ds_read_b64_tr_b16 v[112:113], v6 offset:7168
    ds_read_b64_tr_b16 v[114:115], v6 offset:7424
    v_mfma_f32_32x32x16_bf16 v[64:79], v[32:35], v[24:27], v[64:79]
    ds_read_b64_tr_b16 v[120:121], v6 offset:9216
    ds_read_b64_tr_b16 v[122:123], v6 offset:9472
    s_mul_i32 s22, s31, -24576
    s_add_u32 s22, s22, 73728
    s_add_u32 m0, s34, s22
    s_nop 0
    buffer_load_dwordx4 v3, s[8:11], s21 offen lds
    s_add_u32 s21, s21, 196608
    s_cmp_eq_u32 s21, 1572864
    s_cselect_b32 s21, 0, s21
    v_mfma_f32_32x32x16_bf16 v[80:95], v[40:43], v[24:27], v[80:95]
    s_waitcnt vmcnt(3) lgkmcnt(0)
    s_barrier
    v_mfma_f32_32x32x16_bf16 v[64:79], v[108:111], v[100:103], v[64:79]
    ds_read_b128 v[20:23], v4 offset:16384
    ds_read_b64_tr_b16 v[28:29], v6 offset:12288
    ds_read_b64_tr_b16 v[30:31], v6 offset:12544
    ds_read_b64_tr_b16 v[36:37], v6 offset:14336
    v_mfma_f32_32x32x16_bf16 v[80:95], v[116:119], v[100:103], v[80:95]
    ds_read_b64_tr_b16 v[38:39], v6 offset:14592
    ds_read_b128 v[24:27], v5 offset:16384
    ds_read_b64_tr_b16 v[32:33], v6 offset:13312
    ds_read_b64_tr_b16 v[34:35], v6 offset:13568
    v_mfma_f32_32x32x16_bf16 v[64:79], v[112:115], v[104:107], v[64:79]
    ds_read_b64_tr_b16 v[40:41], v6 offset:15360
    ds_read_b64_tr_b16 v[42:43], v6 offset:15616
    s_add_u32 m0, s33, 0
    s_nop 0
    buffer_load_dwordx4 v2, s[4:7], s20 offen lds
    s_add_u32 m0, s33, 1024
    s_nop 0
    buffer_load_dwordx4 v126, s[4:7], s20 offen lds
    s_add_u32 s20, s20, 128
    s_bitset0_b32 s20, 10
    v_mfma_f32_32x32x16_bf16 v[80:95], v[120:123], v[104:107], v[80:95]
    s_waitcnt lgkmcnt(0)
    s_barrier
    v_mfma_f32_32x32x16_bf16 v[64:79], v[28:31], v[20:23], v[64:79]
    ds_read_b128 v[100:103], v127 offset:16384
    ds_read_b64_tr_b16 v[108:109], v6 offset:18432
    ds_read_b64_tr_b16 v[110:111], v6 offset:18688
    ds_read_b64_tr_b16 v[116:117], v6 offset:20480
    v_mfma_f32_32x32x16_bf16 v[80:95], v[36:39], v[20:23], v[80:95]
    ds_read_b64_tr_b16 v[118:119], v6 offset:20736
    ds_read_b128 v[104:107], v125 offset:16384
    ds_read_b64_tr_b16 v[112:113], v6 offset:19456
    ds_read_b64_tr_b16 v[114:115], v6 offset:19712
    v_mfma_f32_32x32x16_bf16 v[64:79], v[32:35], v[24:27], v[64:79]
    ds_read_b64_tr_b16 v[120:121], v6 offset:21504
    ds_read_b64_tr_b16 v[122:123], v6 offset:21760
    s_mul_i32 s22, s31, 6144
    s_add_u32 s22, s22, 55296
    s_add_u32 m0, s34, s22
    s_nop 0
    buffer_load_dwordx4 v3, s[8:11], s21 offen lds
    s_add_u32 s21, s21, 196608
    s_cmp_eq_u32 s21, 1572864
    s_cselect_b32 s21, 0, s21
    v_mfma_f32_32x32x16_bf16 v[80:95], v[40:43], v[24:27], v[80:95]
    s_waitcnt vmcnt(3) lgkmcnt(0)
    s_barrier
    v_mfma_f32_32x32x16_bf16 v[64:79], v[108:111], v[100:103], v[64:79]
    ds_read_b128 v[20:23], v4 offset:32768
    ds_read_b64_tr_b16 v[28:29], v6 offset:24576
    ds_read_b64_tr_b16 v[30:31], v6 offset:24832
    ds_read_b64_tr_b16 v[36:37], v6 offset:26624
    v_mfma_f32_32x32x16_bf16 v[80:95], v[116:119], v[100:103], v[80:95]
    ds_read_b64_tr_b16 v[38:39], v6 offset:26880
    ds_read_b128 v[24:27], v5 offset:32768
    ds_read_b64_tr_b16 v[32:33], v6 offset:25600
    ds_read_b64_tr_b16 v[34:35], v6 offset:25856
    v_mfma_f32_32x32x16_bf16 v[64:79], v[112:115], v[104:107], v[64:79]
    ds_read_b64_tr_b16 v[40:41], v6 offset:27648
    ds_read_b64_tr_b16 v[42:43], v6 offset:27904
    s_add_u32 m0, s33, 16384
    s_nop 0
    buffer_load_dwordx4 v2, s[4:7], s20 offen lds
    s_add_u32 m0, s33, 17408
    s_nop 0
    buffer_load_dwordx4 v126, s[4:7], s20 offen lds
    s_add_u32 s20, s20, 128
    s_bitset0_b32 s20, 10
    v_mfma_f32_32x32x16_bf16 v[80:95], v[120:123], v[104:107], v[80:95]
    s_waitcnt lgkmcnt(0)
    s_barrier
    v_mfma_f32_32x32x16_bf16 v[64:79], v[28:31], v[20:23], v[64:79]
    ds_read_b128 v[100:103], v127 offset:32768
    ds_read_b64_tr_b16 v[108:109], v6 offset:0
    ds_read_b64_tr_b16 v[110:111], v6 offset:256
    ds_read_b64_tr_b16 v[116:117], v6 offset:2048
    v_mfma_f32_32x32x16_bf16 v[80:95], v[36:39], v[20:23], v[80:95]
    ds_read_b64_tr_b16 v[118:119], v6 offset:2304
    ds_read_b128 v[104:107], v125 offset:32768
    ds_read_b64_tr_b16 v[112:113], v6 offset:1024
    ds_read_b64_tr_b16 v[114:115], v6 offset:1280
    v_mfma_f32_32x32x16_bf16 v[64:79], v[32:35], v[24:27], v[64:79]
    ds_read_b64_tr_b16 v[120:121], v6 offset:3072
    ds_read_b64_tr_b16 v[122:123], v6 offset:3328
    s_mul_i32 s22, s31, 6144
    s_add_u32 s22, s22, 67584
    s_add_u32 m0, s34, s22
    s_nop 0
    buffer_load_dwordx4 v3, s[8:11], s21 offen lds
    s_add_u32 s21, s21, 196608
    s_cmp_eq_u32 s21, 1572864
    s_cselect_b32 s21, 0, s21
    v_mfma_f32_32x32x16_bf16 v[80:95], v[40:43], v[24:27], v[80:95]
    s_waitcnt vmcnt(3) lgkmcnt(0)
    s_barrier
    v_mfma_f32_32x32x16_bf16 v[64:79], v[108:111], v[100:103], v[64:79]
    ds_read_b128 v[20:23], v4 offset:0
    ds_read_b64_tr_b16 v[28:29], v6 offset:6144
    ds_read_b64_tr_b16 v[30:31], v6 offset:6400
    ds_read_b64_tr_b16 v[36:37], v6 offset:8192
    v_mfma_f32_32x32x16_bf16 v[80:95], v[116:119], v[100:103], v[80:95]
    ds_read_b64_tr_b16 v[38:39], v6 offset:8448
    ds_read_b128 v[24:27], v5 offset:0
    ds_read_b64_tr_b16 v[32:33], v6 offset:7168
    ds_read_b64_tr_b16 v[34:35], v6 offset:7424
    v_mfma_f32_32x32x16_bf16 v[64:79], v[112:115], v[104:107], v[64:79]
    ds_read_b64_tr_b16 v[40:41], v6 offset:9216
    ds_read_b64_tr_b16 v[42:43], v6 offset:9472
    s_add_u32 m0, s33, 32768
    s_nop 0
    buffer_load_dwordx4 v2, s[4:7], s20 offen lds
    s_add_u32 m0, s33, 33792
    s_nop 0
    buffer_load_dwordx4 v126, s[4:7], s20 offen lds
    s_add_u32 s20, s20, 128
    s_bitset0_b32 s20, 10
    v_mfma_f32_32x32x16_bf16 v[80:95], v[120:123], v[104:107], v[80:95]
    s_waitcnt lgkmcnt(0)
    s_barrier
    v_mfma_f32_32x32x16_bf16 v[64:79], v[28:31], v[20:23], v[64:79]
    ds_read_b128 v[100:103], v127 offset:0
    ds_read_b64_tr_b16 v[108:109], v6 offset:12288
    ds_read_b64_tr_b16 v[110:111], v6 offset:12544
    ds_read_b64_tr_b16 v[116:117], v6 offset:14336
    v_mfma_f32_32x32x16_bf16 v[80:95], v[36:39], v[20:23], v[80:95]
    ds_read_b64_tr_b16 v[118:119], v6 offset:14592
    ds_read_b128 v[104:107], v125 offset:0
    ds_read_b64_tr_b16 v[112:113], v6 offset:13312
    ds_read_b64_tr_b16 v[114:115], v6 offset:13568
    v_mfma_f32_32x32x16_bf16 v[64:79], v[32:35], v[24:27], v[64:79]
    ds_read_b64_tr_b16 v[120:121], v6 offset:15360
    ds_read_b64_tr_b16 v[122:123], v6 offset:15616
    s_mul_i32 s22, s31, 6144
    s_add_u32 s22, s22, 49152
    s_add_u32 m0, s34, s22
    s_nop 0
    buffer_load_dwordx4 v3, s[8:11], s21 offen lds
    s_add_u32 s21, s21, 196608
    s_cmp_eq_u32 s21, 1572864
    s_cselect_b32 s21, 0, s21
    v_mfma_f32_32x32x16_bf16 v[80:95], v[40:43], v[24:27], v[80:95]
    s_waitcnt vmcnt(3) lgkmcnt(0)
    s_barrier
    v_mfma_f32_32x32x16_bf16 v[64:79], v[108:111], v[100:103], v[64:79]
    ds_read_b128 v[20:23], v4 offset:16384
    ds_read_b64_tr_b16 v[28:29], v6 offset:18432
    ds_read_b64_tr_b16 v[30:31], v6 offset:18688
    ds_read_b64_tr_b16 v[36:37], v6 offset:20480
    v_mfma_f32_32x32x16_bf16 v[80:95], v[116:119], v[100:103], v[80:95]
    ds_read_b64_tr_b16 v[38:39], v6 offset:20736
    ds_read_b128 v[24:27], v5 offset:16384
    ds_read_b64_tr_b16 v[32:33], v6 offset:19456
    ds_read_b64_tr_b16 v[34:35], v6 offset:19712
    v_mfma_f32_32x32x16_bf16 v[64:79], v[112:115], v[104:107], v[64:79]
    ds_read_b64_tr_b16 v[40:41], v6 offset:21504
    ds_read_b64_tr_b16 v[42:43], v6 offset:21760
    s_add_u32 m0, s33, 0
    s_nop 0
    buffer_load_dwordx4 v2, s[4:7], s20 offen lds
    s_add_u32 m0, s33, 1024
    s_nop 0
    buffer_load_dwordx4 v126, s[4:7], s20 offen lds
    s_add_u32 s20, s20, 128
    s_bitset0_b32 s20, 10
    v_mfma_f32_32x32x16_bf16 v[80:95], v[120:123], v[104:107], v[80:95]
    s_waitcnt lgkmcnt(0)
    s_barrier
    v_mfma_f32_32x32x16_bf16 v[64:79], v[28:31], v[20:23], v[64:79]
    ds_read_b128 v[100:103], v127 offset:16384
    ds_read_b64_tr_b16 v[108:109], v6 offset:24576
    ds_read_b64_tr_b16 v[110:111], v6 offset:24832
    ds_read_b64_tr_b16 v[116:117], v6 offset:26624
    v_mfma_f32_32x32x16_bf16 v[80:95], v[36:39], v[20:23], v[80:95]
    ds_read_b64_tr_b16 v[118:119], v6 offset:26880
    ds_read_b128 v[104:107], v125 offset:16384
    ds_read_b64_tr_b16 v[112:113], v6 offset:25600
    ds_read_b64_tr_b16 v[114:115], v6 offset:25856
    v_mfma_f32_32x32x16_bf16 v[64:79], v[32:35], v[24:27], v[64:79]
    ds_read_b64_tr_b16 v[120:121], v6 offset:27648
    ds_read_b64_tr_b16 v[122:123], v6 offset:27904
    s_mul_i32 s22, s31, 6144
    s_add_u32 s22, s22, 61440
    s_add_u32 m0, s34, s22
    s_nop 0
    buffer_load_dwordx4 v3, s[8:11], s21 offen lds
    s_add_u32 s21, s21, 196608
    s_cmp_eq_u32 s21, 1572864
    s_cselect_b32 s21, 0, s21
    v_mfma_f32_32x32x16_bf16 v[80:95], v[40:43], v[24:27], v[80:95]
    s_waitcnt vmcnt(3) lgkmcnt(0)
    s_barrier
    v_mfma_f32_32x32x16_bf16 v[64:79], v[108:111], v[100:103], v[64:79]
    ds_read_b128 v[20:23], v4 offset:32768
    ds_read_b64_tr_b16 v[28:29], v6 offset:0
    ds_read_b64_tr_b16 v[30:31], v6 offset:256
    ds_read_b64_tr_b16 v[36:37], v6 offset:2048
    v_mfma_f32_32x32x16_bf16 v[80:95], v[116:119], v[100:103], v[80:95]
    ds_read_b64_tr_b16 v[38:39], v6 offset:2304
    ds_read_b128 v[24:27], v5 offset:32768
    ds_read_b64_tr_b16 v[32:33], v6 offset:1024
    ds_read_b64_tr_b16 v[34:35], v6 offset:1280
    v_mfma_f32_32x32x16_bf16 v[64:79], v[112:115], v[104:107], v[64:79]
    ds_read_b64_tr_b16 v[40:41], v6 offset:3072
    ds_read_b64_tr_b16 v[42:43], v6 offset:3328
    s_add_u32 m0, s33, 16384
    s_nop 0
    buffer_load_dwordx4 v2, s[4:7], s20 offen lds
    s_add_u32 m0, s33, 17408
    s_nop 0
    buffer_load_dwordx4 v126, s[4:7], s20 offen lds
    s_add_u32 s20, s20, 128
    s_bitset0_b32 s20, 10
    v_mfma_f32_32x32x16_bf16 v[80:95], v[120:123], v[104:107], v[80:95]
    s_waitcnt lgkmcnt(0)
    s_barrier
    v_mfma_f32_32x32x16_bf16 v[64:79], v[28:31], v[20:23], v[64:79]
    ds_read_b128 v[100:103], v127 offset:32768
    ds_read_b64_tr_b16 v[108:109], v6 offset:6144
    ds_read_b64_tr_b16 v[110:111], v6 offset:6400
    ds_read_b64_tr_b16 v[116:117], v6 offset:8192
    v_mfma_f32_32x32x16_bf16 v[80:95], v[36:39], v[20:23], v[80:95]
    ds_read_b64_tr_b16 v[118:119], v6 offset:8448
    ds_read_b128 v[104:107], v125 offset:32768
    ds_read_b64_tr_b16 v[112:113], v6 offset:7168
    ds_read_b64_tr_b16 v[114:115], v6 offset:7424
    v_mfma_f32_32x32x16_bf16 v[64:79], v[32:35], v[24:27], v[64:79]
    ds_read_b64_tr_b16 v[120:121], v6 offset:9216
    ds_read_b64_tr_b16 v[122:123], v6 offset:9472
    s_mul_i32 s22, s31, -24576
    s_add_u32 s22, s22, 73728
    s_add_u32 m0, s34, s22
    s_nop 0
    buffer_load_dwordx4 v3, s[8:11], s21 offen lds
    s_add_u32 s21, s21, 196608
    s_cmp_eq_u32 s21, 1572864
    s_cselect_b32 s21, 0, s21
    v_mfma_f32_32x32x16_bf16 v[80:95], v[40:43], v[24:27], v[80:95]
    s_waitcnt vmcnt(3) lgkmcnt(0)
    s_barrier
    v_mfma_f32_32x32x16_bf16 v[64:79], v[108:111], v[100:103], v[64:79]
    ds_read_b128 v[20:23], v4 offset:0
    ds_read_b64_tr_b16 v[28:29], v6 offset:12288
    ds_read_b64_tr_b16 v[30:31], v6 offset:12544
    ds_read_b64_tr_b16 v[36:37], v6 offset:14336
    v_mfma_f32_32x32x16_bf16 v[80:95], v[116:119], v[100:103], v[80:95]
    ds_read_b64_tr_b16 v[38:39], v6 offset:14592
    ds_read_b128 v[24:27], v5 offset:0
    ds_read_b64_tr_b16 v[32:33], v6 offset:13312
    ds_read_b64_tr_b16 v[34:35], v6 offset:13568
    v_mfma_f32_32x32x16_bf16 v[64:79], v[112:115], v[104:107], v[64:79]
    ds_read_b64_tr_b16 v[40:41], v6 offset:15360
    ds_read_b64_tr_b16 v[42:43], v6 offset:15616
    v_mfma_f32_32x32x16_bf16 v[80:95], v[120:123], v[104:107], v[80:95]
    v_and_b32 v11, 31, v0
    v_lshlrev_b32 v11, 3, v11
    s_lshl_b32 s21, s17, 2
    s_add_u32 s21, s21, s35
    s_lshl_b32 s21, s21, 8
    s_add_u32 s21, s21, 15859712
    buffer_load_dword v14, off, s[40:43], 0 sc0 sc1
    buffer_load_dwordx2 v[12:13], v11, s[12:15], s21 offen sc0 sc1
    v_mov_b32 v2, -1
    v_mov_b32 v3, -1
    v_lshlrev_b32 v1, 3, v0
    buffer_store_dwordx2 v[2:3], v1, s[12:15], s28 offen sc0 sc1
    buffer_store_dwordx2 v[2:3], v1, s[12:15], s28 offen offset:1024 sc0 sc1
    s_waitcnt lgkmcnt(0)
    v_mfma_f32_32x32x16_bf16 v[64:79], v[28:31], v[20:23], v[64:79]
    ds_read_b128 v[100:103], v127 offset:0
    ds_read_b64_tr_b16 v[108:109], v6 offset:18432
    ds_read_b64_tr_b16 v[110:111], v6 offset:18688
    ds_read_b64_tr_b16 v[116:117], v6 offset:20480
    v_mfma_f32_32x32x16_bf16 v[80:95], v[36:39], v[20:23], v[80:95]
    ds_read_b64_tr_b16 v[118:119], v6 offset:20736
    ds_read_b128 v[104:107], v125 offset:0
    ds_read_b64_tr_b16 v[112:113], v6 offset:19456
    ds_read_b64_tr_b16 v[114:115], v6 offset:19712
    v_mfma_f32_32x32x16_bf16 v[64:79], v[32:35], v[24:27], v[64:79]
    ds_read_b64_tr_b16 v[120:121], v6 offset:21504
    ds_read_b64_tr_b16 v[122:123], v6 offset:21760
    v_mfma_f32_32x32x16_bf16 v[80:95], v[40:43], v[24:27], v[80:95]
    s_waitcnt vmcnt(4) lgkmcnt(0)
    s_barrier
    v_mfma_f32_32x32x16_bf16 v[64:79], v[108:111], v[100:103], v[64:79]
    ds_read_b128 v[20:23], v4 offset:16384
    ds_read_b64_tr_b16 v[28:29], v6 offset:24576
    ds_read_b64_tr_b16 v[30:31], v6 offset:24832
    ds_read_b64_tr_b16 v[36:37], v6 offset:26624
    v_mfma_f32_32x32x16_bf16 v[80:95], v[116:119], v[100:103], v[80:95]
    ds_read_b64_tr_b16 v[38:39], v6 offset:26880
    ds_read_b128 v[24:27], v5 offset:16384
    ds_read_b64_tr_b16 v[32:33], v6 offset:25600
    ds_read_b64_tr_b16 v[34:35], v6 offset:25856
    v_mfma_f32_32x32x16_bf16 v[64:79], v[112:115], v[104:107], v[64:79]
    ds_read_b64_tr_b16 v[40:41], v6 offset:27648
    ds_read_b64_tr_b16 v[42:43], v6 offset:27904
    v_mfma_f32_32x32x16_bf16 v[80:95], v[120:123], v[104:107], v[80:95]
    s_waitcnt lgkmcnt(0)
    v_mfma_f32_32x32x16_bf16 v[64:79], v[28:31], v[20:23], v[64:79]
    ds_read_b128 v[100:103], v127 offset:16384
    ds_read_b64_tr_b16 v[108:109], v6 offset:0
    ds_read_b64_tr_b16 v[110:111], v6 offset:256
    ds_read_b64_tr_b16 v[116:117], v6 offset:2048
    v_mfma_f32_32x32x16_bf16 v[80:95], v[36:39], v[20:23], v[80:95]
    ds_read_b64_tr_b16 v[118:119], v6 offset:2304
    ds_read_b128 v[104:107], v125 offset:16384
    ds_read_b64_tr_b16 v[112:113], v6 offset:1024
    ds_read_b64_tr_b16 v[114:115], v6 offset:1280
    v_mfma_f32_32x32x16_bf16 v[64:79], v[32:35], v[24:27], v[64:79]
    ds_read_b64_tr_b16 v[120:121], v6 offset:3072
    ds_read_b64_tr_b16 v[122:123], v6 offset:3328
    v_mfma_f32_32x32x16_bf16 v[80:95], v[40:43], v[24:27], v[80:95]
    s_mov_b32 s53, 200000
    s_waitcnt vmcnt(2)
L_gl1:
    v_readfirstlane_b32 s52, v14
    v_cmp_ne_u32 vcc, v14, v13
    s_cmp_eq_u32 s52, 0
    s_cselect_b32 s24, 1, 0
    s_or_b32 s24, s24, vcc_hi
    s_or_b32 s24, s24, vcc_lo
    s_cbranch_scc0 L_gd2
    s_sub_u32 s53, s53, 1
    s_cbranch_scc1 L_gd2
    s_sleep 2
    buffer_load_dword v14, off, s[40:43], 0 sc0 sc1
    buffer_load_dwordx2 v[12:13], v11, s[12:15], s21 offen sc0 sc1
    s_waitcnt vmcnt(0)
    s_branch L_gl1
L_gd2:
    v_and_b32 v15, 0xffff0000, v12
    v_rcp_f32 v15, v15
    v_and_b32 v49, 0xffff, v12
    v_xor_b32 v49, 0x8000, v49
    v_lshl_or_b32 v48, v49, 16, v49
    s_waitcnt lgkmcnt(0)
    v_mfma_f32_32x32x16_bf16 v[80:95], v[116:119], v[100:103], v[80:95]
    v_mfma_f32_32x32x16_bf16 v[80:95], v[120:123], v[104:107], v[80:95]
    v_mfma_f32_32x32x16_bf16 v[64:79], v[108:111], v[100:103], v[64:79]
    v_mfma_f32_32x32x16_bf16 v[64:79], v[112:115], v[104:107], v[64:79]
    s_waitcnt lgkmcnt(0)
    s_barrier
    s_mov_b32 s24, 0x07060302
    ds_read_b32 v4, v18 offset:128
    ds_read_b32 v5, v18
    s_waitcnt lgkmcnt(1)
    v_and_b32 v10, 0xffff0000, v4
    v_sub_f32 v10, v4, v10
    v_perm_b32 v96, v10, v4, s24
    v_and_b32 v4, 0xffff0000, v10
    v_sub_f32 v10, v10, v4
    v_lshrrev_b32 v97, 16, v10
    s_nop 1
    v_mfma_f32_32x32x16_bf16 v[80:95], v[96:99], v[48:51], v[80:95]
    s_waitcnt lgkmcnt(0)
    v_and_b32 v10, 0xffff0000, v5
    v_sub_f32 v10, v5, v10
    v_perm_b32 v60, v10, v5, s24
    v_and_b32 v5, 0xffff0000, v10
    v_sub_f32 v10, v10, v5
    v_lshrrev_b32 v61, 16, v10
    s_nop 1
    v_mfma_f32_32x32x16_bf16 v[64:79], v[60:63], v[48:51], v[64:79]
    v_mul_f32 v4, 0x3eb8aa3b, v15
    v_mov_b32 v5, v15
    v_mul_f32 v80, v5, v80
    v_mul_f32 v81, v5, v81
    v_mul_f32 v82, v5, v82
    v_mul_f32 v83, v5, v83
    v_mul_f32 v84, v5, v84
    v_mul_f32 v85, v5, v85
    v_mul_f32 v86, v5, v86
    v_mul_f32 v87, v5, v87
    v_cvt_pk_bf16_f32 v20, v80, v81
    v_cvt_pk_bf16_f32 v21, v82, v83
    v_cvt_pk_bf16_f32 v22, v84, v85
    v_cvt_pk_bf16_f32 v23, v86, v87
    s_add_u32 s25, s29, 0
    buffer_store_dwordx4 v[20:23], v16, s[12:15], s25 offen sc0 sc1
    ds_write_b128 v17, v[20:23] offset:32768
    v_mul_f32 v88, v5, v88
    v_mul_f32 v89, v5, v89
    v_mul_f32 v90, v5, v90
    v_mul_f32 v91, v5, v91
    v_mul_f32 v92, v5, v92
    v_mul_f32 v93, v5, v93
    v_mul_f32 v94, v5, v94
    v_mul_f32 v95, v5, v95
    v_cvt_pk_bf16_f32 v24, v88, v89
    v_cvt_pk_bf16_f32 v25, v90, v91
    v_cvt_pk_bf16_f32 v26, v92, v93
    v_cvt_pk_bf16_f32 v27, v94, v95
    s_add_u32 s25, s29, 131072
    buffer_store_dwordx4 v[24:27], v16, s[12:15], s25 offen sc0 sc1
    ds_write_b128 v17, v[24:27] offset:49152
    v_mul_f32 v64, v4, v64
    v_mul_f32 v65, v4, v65
    v_mul_f32 v66, v4, v66
    v_mul_f32 v67, v4, v67
    v_mul_f32 v68, v4, v68
    v_mul_f32 v69, v4, v69
    v_mul_f32 v70, v4, v70
    v_mul_f32 v71, v4, v71
    v_cvt_pk_bf16_f32 v28, v64, v65
    v_cvt_pk_bf16_f32 v29, v66, v67
    v_cvt_pk_bf16_f32 v30, v68, v69
    v_cvt_pk_bf16_f32 v31, v70, v71
    s_bitcmp1_b32 s17, 0
    s_cbranch_scc1 L_qs3
    ds_write_b128 v9, v[28:31] offset:36864
    s_branch L_qd4
L_qs3:
    buffer_store_dwordx4 v[28:31], v44, s[12:15], s23 offen sc0 sc1
L_qd4:
    v_mul_f32 v72, v4, v72
    v_mul_f32 v73, v4, v73
    v_mul_f32 v74, v4, v74
    v_mul_f32 v75, v4, v75
    v_mul_f32 v76, v4, v76
    v_mul_f32 v77, v4, v77
    v_mul_f32 v78, v4, v78
    v_mul_f32 v79, v4, v79
    v_cvt_pk_bf16_f32 v32, v72, v73
    v_cvt_pk_bf16_f32 v33, v74, v75
    v_cvt_pk_bf16_f32 v34, v76, v77
    v_cvt_pk_bf16_f32 v35, v78, v79
    s_bitcmp0_b32 s17, 0
    s_cbranch_scc1 L_qs5
    ds_write_b128 v9, v[32:35] offset:36864
    s_branch L_qd6
L_qs5:
    buffer_store_dwordx4 v[32:35], v44, s[12:15], s23 offen sc0 sc1
L_qd6:
    s_branch L_a_epi_done
L_a_vloop:
    s_lshl_b32 s24, s35, 10
    v_lshl_add_u32 v17, v47, 14, v16
    v_add_u32 v17, s24, v17
    v_lshl_add_u32 v16, v47, 17, v16
    s_and_b32 s24, s35, 2
    s_lshl_b32 s24, s24, 4
    v_xor_b32 v4, s24, v4
    s_lshl_b32 s24, s24, 5
    v_add_u32 v6, s24, v6
    v_xor_b32 v7, 1024, v6
    s_and_b32 s25, s35, 1
    s_lshl_b32 s24, s25, 11
    v_add_u32 v8, s24, v6
    s_lshr_b32 s24, s35, 1
    s_mul_i32 s24, s24, 384
    s_add_u32 s24, s24, 80384
    v_lshl_add_u32 v9, v10, 2, s24
    s_lshl_b32 s25, s25, 7
    v_add_u32 v19, s25, v9
    v_xor_b32 v47, 1, v47
    v_xor_b32 v5, 32, v4
    v_xor_b32 v127, 64, v4
    v_xor_b32 v125, 96, v4
    s_waitcnt vmcnt(4) lgkmcnt(0)
    s_barrier
    ds_read_b128 v[20:23], v4 offset:0
    ds_read_b64_tr_b16 v[28:29], v6 offset:4096
    ds_read_b64_tr_b16 v[30:31], v6 offset:4352
    ds_read_b128 v[24:27], v5 offset:0
    ds_read_b64_tr_b16 v[32:33], v7 offset:4096
    ds_read_b64_tr_b16 v[34:35], v7 offset:4352
    ds_read_b64_tr_b16 v[36:37], v8 offset:0
    ds_read_b64_tr_b16 v[38:39], v8 offset:256
    s_add_u32 m0, s33, 32768
    s_nop 0
    buffer_load_dwordx4 v2, s[4:7], s20 offen lds
    s_add_u32 m0, s33, 33792
    s_nop 0
    buffer_load_dwordx4 v126, s[4:7], s20 offen lds
    s_add_u32 s20, s20, 128
    s_bitset0_b32 s20, 10
    s_waitcnt lgkmcnt(0)
    s_barrier
    v_mfma_f32_32x32x16_bf16 v[64:79], v[20:23], v[28:31], v[64:79]
    ds_read_b128 v[100:103], v127 offset:0
    ds_read_b64_tr_b16 v[108:109], v6 offset:10240
    ds_read_b64_tr_b16 v[110:111], v6 offset:10496
    ds_read_b128 v[104:107], v125 offset:0
    v_mfma_f32_32x32x16_bf16 v[64:79], v[24:27], v[32:35], v[64:79]
    ds_read_b64_tr_b16 v[112:113], v7 offset:10240
    ds_read_b64_tr_b16 v[114:115], v7 offset:10496
    ds_read_b64_tr_b16 v[116:117], v8 offset:6144
    ds_read_b64_tr_b16 v[118:119], v8 offset:6400
    v_mfma_f32_16x16x32_bf16 v[60:63], v[52:55], v[36:39], v[60:63]
    s_add_u32 m0, s34, 73728
    s_add_u32 s22, s21, 98304
    buffer_load_dwordx4 v3, s[8:11], s21 offen lds
    s_add_u32 m0, s34, 49152
    s_add_u32 s21, s21, 196608
    buffer_load_dwordx4 v3, s[8:11], s22 offen lds
    s_cmp_eq_u32 s21, 1572864
    s_cselect_b32 s21, 0, s21
    v_mfma_f32_16x16x32_bf16 v[56:59], v[52:55], v[28:31], v[56:59]
    s_waitcnt vmcnt(4) lgkmcnt(0)
    s_barrier
    v_mfma_f32_32x32x16_bf16 v[64:79], v[100:103], v[108:111], v[64:79]
    ds_read_b128 v[20:23], v4 offset:16384
    ds_read_b64_tr_b16 v[28:29], v6 offset:16384
    ds_read_b64_tr_b16 v[30:31], v6 offset:16640
    ds_read_b128 v[24:27], v5 offset:16384
    v_mfma_f32_32x32x16_bf16 v[64:79], v[104:107], v[112:115], v[64:79]
    ds_read_b64_tr_b16 v[32:33], v7 offset:16384
    ds_read_b64_tr_b16 v[34:35], v7 offset:16640
    ds_read_b64_tr_b16 v[36:37], v8 offset:12288
    ds_read_b64_tr_b16 v[38:39], v8 offset:12544
    v_mfma_f32_16x16x32_bf16 v[60:63], v[52:55], v[116:119], v[60:63]
    s_add_u32 m0, s33, 0
    s_nop 0
    buffer_load_dwordx4 v2, s[4:7], s20 offen lds
    s_add_u32 m0, s33, 1024
    s_nop 0
    buffer_load_dwordx4 v126, s[4:7], s20 offen lds
    s_add_u32 s20, s20, 128
    s_bitset0_b32 s20, 10
    v_mfma_f32_16x16x32_bf16 v[56:59], v[52:55], v[108:111], v[56:59]
    s_waitcnt lgkmcnt(0)
    s_barrier
    v_mfma_f32_32x32x16_bf16 v[64:79], v[20:23], v[28:31], v[64:79]
    ds_read_b128 v[100:103], v127 offset:16384
    ds_read_b64_tr_b16 v[108:109], v6 offset:22528
    ds_read_b64_tr_b16 v[110:111], v6 offset:22784
    ds_read_b128 v[104:107], v125 offset:16384
    v_mfma_f32_32x32x16_bf16 v[64:79], v[24:27], v[32:35], v[64:79]
    ds_read_b64_tr_b16 v[112:113], v7 offset:22528
    ds_read_b64_tr_b16 v[114:115], v7 offset:22784
    ds_read_b64_tr_b16 v[116:117], v8 offset:18432
    ds_read_b64_tr_b16 v[118:119], v8 offset:18688
    v_mfma_f32_16x16x32_bf16 v[60:63], v[52:55], v[36:39], v[60:63]
    s_add_u32 m0, s34, 55296
    s_add_u32 s22, s21, 98304
    buffer_load_dwordx4 v3, s[8:11], s21 offen lds
    s_add_u32 m0, s34, 61440
    s_add_u32 s21, s21, 196608
    buffer_load_dwordx4 v3, s[8:11], s22 offen lds
    s_cmp_eq_u32 s21, 1572864
    s_cselect_b32 s21, 0, s21
    v_mfma_f32_16x16x32_bf16 v[56:59], v[52:55], v[28:31], v[56:59]
    s_waitcnt vmcnt(4) lgkmcnt(0)
    s_barrier
    v_mfma_f32_32x32x16_bf16 v[64:79], v[100:103], v[108:111], v[64:79]
    ds_read_b128 v[20:23], v4 offset:32768
    ds_read_b64_tr_b16 v[28:29], v6 offset:28672
    ds_read_b64_tr_b16 v[30:31], v6 offset:28928
    ds_read_b128 v[24:27], v5 offset:32768
    v_mfma_f32_32x32x16_bf16 v[64:79], v[104:107], v[112:115], v[64:79]
    ds_read_b64_tr_b16 v[32:33], v7 offset:28672
    ds_read_b64_tr_b16 v[34:35], v7 offset:28928
    ds_read_b64_tr_b16 v[36:37], v8 offset:24576
    ds_read_b64_tr_b16 v[38:39], v8 offset:24832
    v_mfma_f32_16x16x32_bf16 v[60:63], v[52:55], v[116:119], v[60:63]
    s_add_u32 m0, s33, 16384
    s_nop 0
    buffer_load_dwordx4 v2, s[4:7], s20 offen lds
    s_add_u32 m0, s33, 17408
    s_nop 0
    buffer_load_dwordx4 v126, s[4:7], s20 offen lds
    s_add_u32 s20, s20, 128
    s_bitset0_b32 s20, 10
    v_mfma_f32_16x16x32_bf16 v[56:59], v[52:55], v[108:111], v[56:59]
    s_waitcnt lgkmcnt(0)
    s_barrier
    v_mfma_f32_32x32x16_bf16 v[64:79], v[20:23], v[28:31], v[64:79]
    ds_read_b128 v[100:103], v127 offset:32768
    ds_read_b64_tr_b16 v[108:109], v6 offset:4096
    ds_read_b64_tr_b16 v[110:111], v6 offset:4352
    ds_read_b128 v[104:107], v125 offset:32768
    v_mfma_f32_32x32x16_bf16 v[64:79], v[24:27], v[32:35], v[64:79]
    ds_read_b64_tr_b16 v[112:113], v7 offset:4096
    ds_read_b64_tr_b16 v[114:115], v7 offset:4352
    ds_read_b64_tr_b16 v[116:117], v8 offset:0
    ds_read_b64_tr_b16 v[118:119], v8 offset:256
    v_mfma_f32_16x16x32_bf16 v[60:63], v[52:55], v[36:39], v[60:63]
    s_add_u32 m0, s34, 67584
    s_add_u32 s22, s21, 98304
    buffer_load_dwordx4 v3, s[8:11], s21 offen lds
    s_add_u32 m0, s34, 73728
    s_add_u32 s21, s21, 196608
    buffer_load_dwordx4 v3, s[8:11], s22 offen lds
    s_cmp_eq_u32 s21, 1572864
    s_cselect_b32 s21, 0, s21
    v_mfma_f32_16x16x32_bf16 v[56:59], v[52:55], v[28:31], v[56:59]
    s_waitcnt vmcnt(4) lgkmcnt(0)
    s_barrier
    v_mfma_f32_32x32x16_bf16 v[64:79], v[100:103], v[108:111], v[64:79]
    ds_read_b128 v[20:23], v4 offset:0
    ds_read_b64_tr_b16 v[28:29], v6 offset:10240
    ds_read_b64_tr_b16 v[30:31], v6 offset:10496
    ds_read_b128 v[24:27], v5 offset:0
    v_mfma_f32_32x32x16_bf16 v[64:79], v[104:107], v[112:115], v[64:79]
    ds_read_b64_tr_b16 v[32:33], v7 offset:10240
    ds_read_b64_tr_b16 v[34:35], v7 offset:10496
    ds_read_b64_tr_b16 v[36:37], v8 offset:6144
    ds_read_b64_tr_b16 v[38:39], v8 offset:6400
    v_mfma_f32_16x16x32_bf16 v[60:63], v[52:55], v[116:119], v[60:63]
    s_add_u32 m0, s33, 32768
    s_nop 0
    buffer_load_dwordx4 v2, s[4:7], s20 offen lds
    s_add_u32 m0, s33, 33792
    s_nop 0
    buffer_load_dwordx4 v126, s[4:7], s20 offen lds
    s_add_u32 s20, s20, 128
    s_bitset0_b32 s20, 10
    v_mfma_f32_16x16x32_bf16 v[56:59], v[52:55], v[108:111], v[56:59]
    s_waitcnt lgkmcnt(0)
    s_barrier
    v_mfma_f32_32x32x16_bf16 v[64:79], v[20:23], v[28:31], v[64:79]
    ds_read_b128 v[100:103], v127 offset:0
    ds_read_b64_tr_b16 v[108:109], v6 offset:16384
    ds_read_b64_tr_b16 v[110:111], v6 offset:16640
    ds_read_b128 v[104:107], v125 offset:0
    v_mfma_f32_32x32x16_bf16 v[64:79], v[24:27], v[32:35], v[64:79]
    ds_read_b64_tr_b16 v[112:113], v7 offset:16384
    ds_read_b64_tr_b16 v[114:115], v7 offset:16640
    ds_read_b64_tr_b16 v[116:117], v8 offset:12288
    ds_read_b64_tr_b16 v[118:119], v8 offset:12544
    v_mfma_f32_16x16x32_bf16 v[60:63], v[52:55], v[36:39], v[60:63]
    s_add_u32 m0, s34, 49152
    s_add_u32 s22, s21, 98304
    buffer_load_dwordx4 v3, s[8:11], s21 offen lds
    s_add_u32 m0, s34, 55296
    s_add_u32 s21, s21, 196608
    buffer_load_dwordx4 v3, s[8:11], s22 offen lds
    s_cmp_eq_u32 s21, 1572864
    s_cselect_b32 s21, 0, s21
    v_mfma_f32_16x16x32_bf16 v[56:59], v[52:55], v[28:31], v[56:59]
    s_waitcnt vmcnt(4) lgkmcnt(0)
    s_barrier
    v_mfma_f32_32x32x16_bf16 v[64:79], v[100:103], v[108:111], v[64:79]
    ds_read_b128 v[20:23], v4 offset:16384
    ds_read_b64_tr_b16 v[28:29], v6 offset:22528
    ds_read_b64_tr_b16 v[30:31], v6 offset:22784
    ds_read_b128 v[24:27], v5 offset:16384
    v_mfma_f32_32x32x16_bf16 v[64:79], v[104:107], v[112:115], v[64:79]
    ds_read_b64_tr_b16 v[32:33], v7 offset:22528
    ds_read_b64_tr_b16 v[34:35], v7 offset:22784
    ds_read_b64_tr_b16 v[36:37], v8 offset:18432
    ds_read_b64_tr_b16 v[38:39], v8 offset:18688
    v_mfma_f32_16x16x32_bf16 v[60:63], v[52:55], v[116:119], v[60:63]
    s_add_u32 m0, s33, 0
    s_nop 0
    buffer_load_dwordx4 v2, s[4:7], s20 offen lds
    s_add_u32 m0, s33, 1024
    s_nop 0
    buffer_load_dwordx4 v126, s[4:7], s20 offen lds
    s_add_u32 s20, s20, 128
    s_bitset0_b32 s20, 10
    v_mfma_f32_16x16x32_bf16 v[56:59], v[52:55], v[108:111], v[56:59]
    s_waitcnt lgkmcnt(0)
    s_barrier
    v_mfma_f32_32x32x16_bf16 v[64:79], v[20:23], v[28:31], v[64:79]
    ds_read_b128 v[100:103], v127 offset:16384
    ds_read_b64_tr_b16 v[108:109], v6 offset:28672
    ds_read_b64_tr_b16 v[110:111], v6 offset:28928
    ds_read_b128 v[104:107], v125 offset:16384
    v_mfma_f32_32x32x16_bf16 v[64:79], v[24:27], v[32:35], v[64:79]
    ds_read_b64_tr_b16 v[112:113], v7 offset:28672
    ds_read_b64_tr_b16 v[114:115], v7 offset:28928
    ds_read_b64_tr_b16 v[116:117], v8 offset:24576
    ds_read_b64_tr_b16 v[118:119], v8 offset:24832
    v_mfma_f32_16x16x32_bf16 v[60:63], v[52:55], v[36:39], v[60:63]
    s_add_u32 m0, s34, 61440
    s_add_u32 s22, s21, 98304
    buffer_load_dwordx4 v3, s[8:11], s21 offen lds
    s_add_u32 m0, s34, 67584
    s_add_u32 s21, s21, 196608
    buffer_load_dwordx4 v3, s[8:11], s22 offen lds
    s_cmp_eq_u32 s21, 1572864
    s_cselect_b32 s21, 0, s21
    v_mfma_f32_16x16x32_bf16 v[56:59], v[52:55], v[28:31], v[56:59]
    s_waitcnt vmcnt(4) lgkmcnt(0)
    s_barrier
    v_mfma_f32_32x32x16_bf16 v[64:79], v[100:103], v[108:111], v[64:79]
    ds_read_b128 v[20:23], v4 offset:32768
    ds_read_b64_tr_b16 v[28:29], v6 offset:4096
    ds_read_b64_tr_b16 v[30:31], v6 offset:4352
    ds_read_b128 v[24:27], v5 offset:32768
    v_mfma_f32_32x32x16_bf16 v[64:79], v[104:107], v[112:115], v[64:79]
    ds_read_b64_tr_b16 v[32:33], v7 offset:4096
    ds_read_b64_tr_b16 v[34:35], v7 offset:4352
    ds_read_b64_tr_b16 v[36:37], v8 offset:0
    ds_read_b64_tr_b16 v[38:39], v8 offset:256
    v_mfma_f32_16x16x32_bf16 v[60:63], v[52:55], v[116:119], v[60:63]
    s_add_u32 m0, s33, 16384
    s_nop 0
    buffer_load_dwordx4 v2, s[4:7], s20 offen lds
    s_add_u32 m0, s33, 17408
    s_nop 0
    buffer_load_dwordx4 v126, s[4:7], s20 offen lds
    s_add_u32 s20, s20, 128
    s_bitset0_b32 s20, 10
    v_mfma_f32_16x16x32_bf16 v[56:59], v[52:55], v[108:111], v[56:59]
    s_waitcnt lgkmcnt(0)
    s_barrier
    v_mfma_f32_32x32x16_bf16 v[64:79], v[20:23], v[28:31], v[64:79]
    ds_read_b128 v[100:103], v127 offset:32768
    ds_read_b64_tr_b16 v[108:109], v6 offset:10240
    ds_read_b64_tr_b16 v[110:111], v6 offset:10496
    ds_read_b128 v[104:107], v125 offset:32768
    v_mfma_f32_32x32x16_bf16 v[64:79], v[24:27], v[32:35], v[64:79]
    ds_read_b64_tr_b16 v[112:113], v7 offset:10240
    ds_read_b64_tr_b16 v[114:115], v7 offset:10496
    ds_read_b64_tr_b16 v[116:117], v8 offset:6144
    ds_read_b64_tr_b16 v[118:119], v8 offset:6400
    v_mfma_f32_16x16x32_bf16 v[60:63], v[52:55], v[36:39], v[60:63]
    s_add_u32 m0, s34, 73728
    s_add_u32 s22, s21, 98304
    buffer_load_dwordx4 v3, s[8:11], s21 offen lds
    s_add_u32 m0, s34, 49152
    s_add_u32 s21, s21, 196608
    buffer_load_dwordx4 v3, s[8:11], s22 offen lds
    s_cmp_eq_u32 s21, 1572864
    s_cselect_b32 s21, 0, s21
    v_mfma_f32_16x16x32_bf16 v[56:59], v[52:55], v[28:31], v[56:59]
    s_waitcnt vmcnt(4) lgkmcnt(0)
    s_barrier
    v_mfma_f32_32x32x16_bf16 v[64:79], v[100:103], v[108:111], v[64:79]
    ds_read_b128 v[20:23], v4 offset:0
    ds_read_b64_tr_b16 v[28:29], v6 offset:16384
    ds_read_b64_tr_b16 v[30:31], v6 offset:16640
    ds_read_b128 v[24:27], v5 offset:0
    v_mfma_f32_32x32x16_bf16 v[64:79], v[104:107], v[112:115], v[64:79]
    ds_read_b64_tr_b16 v[32:33], v7 offset:16384
    ds_read_b64_tr_b16 v[34:35], v7 offset:16640
    ds_read_b64_tr_b16 v[36:37], v8 offset:12288
    ds_read_b64_tr_b16 v[38:39], v8 offset:12544
    v_mfma_f32_16x16x32_bf16 v[60:63], v[52:55], v[116:119], v[60:63]
    v_mfma_f32_16x16x32_bf16 v[56:59], v[52:55], v[108:111], v[56:59]
    v_and_b32 v11, 31, v0
    v_lshlrev_b32 v11, 3, v11
    s_lshl_b32 s21, s17, 2
    s_add_u32 s21, s21, s35
    s_lshl_b32 s21, s21, 8
    s_add_u32 s21, s21, 15859712
    buffer_load_dword v14, off, s[40:43], 0 sc0 sc1
    buffer_load_dwordx2 v[12:13], v11, s[12:15], s21 offen sc0 sc1
    v_mov_b32 v2, -1
    v_mov_b32 v3, -1
    v_lshlrev_b32 v1, 3, v0
    buffer_store_dwordx2 v[2:3], v1, s[12:15], s28 offen sc0 sc1
    buffer_store_dwordx2 v[2:3], v1, s[12:15], s28 offen offset:1024 sc0 sc1
    s_waitcnt lgkmcnt(0)
    v_mfma_f32_32x32x16_bf16 v[64:79], v[20:23], v[28:31], v[64:79]
    ds_read_b128 v[100:103], v127 offset:0
    ds_read_b64_tr_b16 v[108:109], v6 offset:22528
    ds_read_b64_tr_b16 v[110:111], v6 offset:22784
    ds_read_b128 v[104:107], v125 offset:0
    v_mfma_f32_32x32x16_bf16 v[64:79], v[24:27], v[32:35], v[64:79]
    ds_read_b64_tr_b16 v[112:113], v7 offset:22528
    ds_read_b64_tr_b16 v[114:115], v7 offset:22784
    ds_read_b64_tr_b16 v[116:117], v8 offset:18432
    ds_read_b64_tr_b16 v[118:119], v8 offset:18688
    v_mfma_f32_16x16x32_bf16 v[60:63], v[52:55], v[36:39], v[60:63]
    v_mfma_f32_16x16x32_bf16 v[56:59], v[52:55], v[28:31], v[56:59]
    s_waitcnt vmcnt(4) lgkmcnt(0)
    s_barrier
    v_mfma_f32_32x32x16_bf16 v[64:79], v[100:103], v[108:111], v[64:79]
    ds_read_b128 v[20:23], v4 offset:16384
    ds_read_b64_tr_b16 v[28:29], v6 offset:28672
    ds_read_b64_tr_b16 v[30:31], v6 offset:28928
    ds_read_b128 v[24:27], v5 offset:16384
    v_mfma_f32_32x32x16_bf16 v[64:79], v[104:107], v[112:115], v[64:79]
    ds_read_b64_tr_b16 v[32:33], v7 offset:28672
    ds_read_b64_tr_b16 v[34:35], v7 offset:28928
    ds_read_b64_tr_b16 v[36:37], v8 offset:24576
    ds_read_b64_tr_b16 v[38:39], v8 offset:24832
    v_mfma_f32_16x16x32_bf16 v[60:63], v[52:55], v[116:119], v[60:63]
    v_mfma_f32_16x16x32_bf16 v[56:59], v[52:55], v[108:111], v[56:59]
    s_waitcnt lgkmcnt(0)
    v_mfma_f32_32x32x16_bf16 v[64:79], v[20:23], v[28:31], v[64:79]
    ds_read_b128 v[100:103], v127 offset:16384
    ds_read_b64_tr_b16 v[108:109], v6 offset:4096
    ds_read_b64_tr_b16 v[110:111], v6 offset:4352
    ds_read_b128 v[104:107], v125 offset:16384
    v_mfma_f32_32x32x16_bf16 v[64:79], v[24:27], v[32:35], v[64:79]
    ds_read_b64_tr_b16 v[112:113], v7 offset:4096
    ds_read_b64_tr_b16 v[114:115], v7 offset:4352
    ds_read_b64_tr_b16 v[116:117], v8 offset:0
    ds_read_b64_tr_b16 v[118:119], v8 offset:256
    v_mfma_f32_16x16x32_bf16 v[60:63], v[52:55], v[36:39], v[60:63]
    v_mfma_f32_16x16x32_bf16 v[56:59], v[52:55], v[28:31], v[56:59]
    s_mov_b32 s53, 200000
    s_waitcnt vmcnt(2)
L_gl7:
    v_readfirstlane_b32 s52, v14
    v_cmp_ne_u32 vcc, v14, v13
    s_cmp_eq_u32 s52, 0
    s_cselect_b32 s24, 1, 0
    s_or_b32 s24, s24, vcc_hi
    s_or_b32 s24, s24, vcc_lo
    s_cbranch_scc0 L_gd8
    s_sub_u32 s53, s53, 1
    s_cbranch_scc1 L_gd8
    s_sleep 2
    buffer_load_dword v14, off, s[40:43], 0 sc0 sc1
    buffer_load_dwordx2 v[12:13], v11, s[12:15], s21 offen sc0 sc1
    s_waitcnt vmcnt(0)
    s_branch L_gl7
L_gd8:
    v_and_b32 v15, 0xffff0000, v12
    v_rcp_f32 v15, v15
    v_and_b32 v49, 0xffff, v12
    v_xor_b32 v49, 0x8000, v49
    v_lshl_or_b32 v48, v49, 16, v49
    s_lshl_b32 s24, s35, 7
    s_add_u32 s24, s24, 79872
    v_lshrrev_b32 v11, 1, v11
    v_add_u32 v11, s24, v11
    ds_write_b32 v11, v15
    v_lshrrev_b32 v11, 5, v0
    v_lshl_add_u32 v11, v11, 4, s24
    s_waitcnt lgkmcnt(0)
    v_mfma_f32_16x16x32_bf16 v[60:63], v[52:55], v[116:119], v[60:63]
    v_mfma_f32_16x16x32_bf16 v[56:59], v[52:55], v[108:111], v[56:59]
    ds_read_b128 v[80:83], v11 offset:0
    ds_read_b128 v[84:87], v11 offset:32
    ds_read_b128 v[88:91], v11 offset:64
    ds_read_b128 v[92:95], v11 offset:96
    s_mov_b64 exec, 0xffff
    s_nop 1
    ds_write_b32 v19, v60
    ds_write_b32 v19, v61 offset:64
    ds_write_b32 v9, v56 offset:256
    ds_write_b32 v9, v57 offset:320
    s_mov_b64 exec, -1
    v_mfma_f32_32x32x16_bf16 v[64:79], v[100:103], v[108:111], v[64:79]
    v_mfma_f32_32x32x16_bf16 v[64:79], v[104:107], v[112:115], v[64:79]
    s_waitcnt lgkmcnt(0)
    s_barrier
    s_mov_b32 s24, 0x07060302
    ds_read_b32 v4, v18 offset:256
    s_mov_b32 s25, s29
    s_waitcnt lgkmcnt(0)
    v_and_b32 v10, 0xffff0000, v4
    v_sub_f32 v10, v4, v10
    v_perm_b32 v96, v10, v4, s24
    v_and_b32 v4, 0xffff0000, v10
    v_sub_f32 v10, v10, v4
    v_lshrrev_b32 v97, 16, v10
    s_nop 1
    v_mfma_f32_32x32x16_bf16 v[64:79], v[48:51], v[96:99], v[64:79]
    s_nop 11
    v_mul_f32 v64, v80, v64
    v_mul_f32 v65, v81, v65
    v_mul_f32 v66, v82, v66
    v_mul_f32 v67, v83, v67
    v_mul_f32 v68, v84, v68
    v_mul_f32 v69, v85, v69
    v_mul_f32 v70, v86, v70
    v_mul_f32 v71, v87, v71
    v_cvt_pk_bf16_f32 v20, v64, v65
    v_cvt_pk_bf16_f32 v21, v66, v67
    v_cvt_pk_bf16_f32 v22, v68, v69
    v_cvt_pk_bf16_f32 v23, v70, v71
    buffer_store_dwordx4 v[20:23], v16, s[12:15], s25 offen offset:0 sc0 sc1
    ds_write_b128 v17, v[20:23] offset:40960
    v_mul_f32 v72, v88, v72
    v_mul_f32 v73, v89, v73
    v_mul_f32 v74, v90, v74
    v_mul_f32 v75, v91, v75
    v_mul_f32 v76, v92, v76
    v_mul_f32 v77, v93, v77
    v_mul_f32 v78, v94, v78
    v_mul_f32 v79, v95, v79
    v_cvt_pk_bf16_f32 v24, v72, v73
    v_cvt_pk_bf16_f32 v25, v74, v75
    v_cvt_pk_bf16_f32 v26, v76, v77
    v_cvt_pk_bf16_f32 v27, v78, v79
    buffer_store_dwordx4 v[24:27], v16, s[12:15], s25 offen offset:512 sc0 sc1
    ds_write_b128 v17, v[24:27] offset:41472
L_a_epi_done:
    v_and_b32 v10, 11, v0
    v_cmp_eq_u32 vcc, 0, v10
    v_mov_b32 v11, 0x3f803f80
    s_nop 0
    v_cndmask_b32 v36, 0, v11, vcc
    s_lshl_b32 s24, s16, 10
    s_add_u32 s24, s24, 65536
    v_add_u32 v10, s24, v44
    v_mov_b32 v37, v36
    v_mov_b32 v38, v36
    v_mov_b32 v39, v36
    ds_write_b128 v10, v[36:39]
    v_mov_b32 v2, v44
    v_add_u32 v3, 65536, v44
    v_mov_b32 v4, v45
    v_mov_b32 v5, v46
    v_lshlrev_b32 v6, 14, v47
    v_mov_b32 v7, 0xdddddddd
    s_lshl_b32 s24, s35, 10
    s_and_b32 s25, s16, 4
    s_lshl_b32 s25, s25, 11
    s_add_u32 s24, s24, s25
    s_add_u32 s24, s24, 36864
    v_add_u32 v8, s24, v44
    v_xor_b32 v9, 1024, v8
    v_add_u32 v1, s30, v44
    s_lshl_b32 s20, s18, 1
    s_and_b32 s24, s17, 1
    s_add_u32 s20, s20, s24
    s_lshl_b32 s20, s20, 17
    s_xor_b32 s31, s17, 1
    s_lshl_b32 s32, s31, 12
    s_add_u32 s32, s32, s20
    s_or_b32 s21, s32, 4096
    s_add_u32 s21, s21, 4096
    s_bitset0_b32 s21, 16
    s_lshl_b32 s22, s16, 10
    s_and_b32 s34, s16, 1
    s_lshl_b32 s34, s34, 12
    s_add_u32 s33, s21, s34
    s_add_u32 s21, s21, s22
    s_add_u32 s22, s22, 16384
    s_xor_b32 s23, s23, 65536
    s_mov_b32 s56, s12
    s_mov_b32 s57, s13
    s_mov_b32 s58, 4194304
    s_mov_b32 s59, 0x00020000
    v_mov_b32 v64, 0
    v_mov_b32 v65, 0
    v_mov_b32 v66, 0
    v_mov_b32 v67, 0
    v_mov_b32 v68, 0
    v_mov_b32 v69, 0
    v_mov_b32 v70, 0
    v_mov_b32 v71, 0
    v_mov_b32 v72, 0
    v_mov_b32 v73, 0
    v_mov_b32 v74, 0
    v_mov_b32 v75, 0
    v_mov_b32 v76, 0
    v_mov_b32 v77, 0
    v_mov_b32 v78, 0
    v_mov_b32 v79, 0
    v_mov_b32 v80, 0
    v_mov_b32 v81, 0
    v_mov_b32 v82, 0
    v_mov_b32 v83, 0
    v_mov_b32 v84, 0
    v_mov_b32 v85, 0
    v_mov_b32 v86, 0
    v_mov_b32 v87, 0
    v_mov_b32 v88, 0
    v_mov_b32 v89, 0
    v_mov_b32 v90, 0
    v_mov_b32 v91, 0
    v_mov_b32 v92, 0
    v_mov_b32 v93, 0
    v_mov_b32 v94, 0
    v_mov_b32 v95, 0
    s_waitcnt vmcnt(0) lgkmcnt(0)
    s_barrier
    s_cmp_lg_u32 s16, 0
    s_cbranch_scc1 L_a_nopub
    s_lshl_b32 s24, s18, 12
    s_lshl_b32 s25, s17, 7
    s_add_u32 s24, s24, s25
    s_add_u32 s24, s24, 15990784
    v_mov_b32 v10, s52
    v_mul_u32_u24 v11, 2048, v0
    s_mov_b64 exec, 3
    buffer_store_dword v10, v11, s[12:15], s24 offen sc0 sc1
    s_mov_b64 exec, -1
L_a_nopub:
    s_cmp_lt_u32 s16, 4
    s_cbranch_scc1 L_a_nowait
    s_cmp_ge_u32 s16, 6
    s_cbranch_scc1 L_a_nopoll
    s_lshl_b32 s24, s18, 12
    s_lshl_b32 s25, s31, 7
    s_add_u32 s24, s24, s25
    s_add_u32 s24, s24, 15990784
    s_add_u32 s24, s24, s12
    s_addc_u32 s25, s13, 0
    s_mov_b32 s53, 200000
L_fw9:
    s_load_dword s86, s[24:25], 0 glc
    s_waitcnt lgkmcnt(0)
    s_xor_b32 s86, s86, s52
    s_cbranch_scc0 L_fd10
    s_sub_u32 s53, s53, 1
    s_cbranch_scc1 L_fd10
    s_sleep 1
    s_branch L_fw9
L_fd10:
    s_lshl_b32 s24, s35, 11
    s_lshl_b32 s25, s35, 14
    s_add_u32 s23, s23, s25
    s_add_u32 m0, s24, 45056
    s_add_u32 s25, s23, 15360
    buffer_load_dwordx4 v2, s[12:15], s23 offen sc1 lds
    buffer_load_dwordx4 v2, s[12:15], s25 offen offset:1024 sc1 lds
    s_add_u32 m0, s24, 4096
    s_add_u32 s32, s32, s24
    buffer_load_dwordx4 v2, s[56:59], s32 offen offset:0 sc1 lds
    buffer_load_dwordx4 v2, s[56:59], s32 offen offset:1024 sc1 lds
    s_add_u32 m0, s24, 12288
    s_nop 0
    buffer_load_dwordx4 v3, s[56:59], s32 offen offset:0 sc1 lds
    buffer_load_dwordx4 v3, s[56:59], s32 offen offset:1024 sc1 lds
L_a_nopoll:
    s_waitcnt vmcnt(0)
    s_barrier
    s_branch L_a_own
L_a_nowait:
    s_setprio 2
L_a_own:
    ds_read_b128 v[28:31], v1 offset:32768
    ds_read_b128 v[12:15], v8
    ds_read_b128 v[16:19], v9
    ds_read_b128 v[20:23], v4
    ds_read_b128 v[24:27], v5
    s_waitcnt lgkmcnt(2)
    v_mfma_f32_32x32x16_bf16 v[32:47], v[28:31], v[12:15], 0
    v_mfma_f32_32x32x16_bf16 v[48:63], v[28:31], v[16:19], 0
    s_nop 10
    v_max3_f32 v10, v32, v33, v34
    v_max3_f32 v10, v10, v35, v36
    v_max3_f32 v10, v10, v37, v38
    v_max3_f32 v10, v10, v39, v40
    v_max3_f32 v10, v10, v41, v42
    v_max3_f32 v10, v10, v43, v44
    v_max3_f32 v10, v10, v45, v46
    v_max_f32 v10, v10, v47
    v_mov_b32 v11, v10
    s_nop 1
    v_permlane32_swap_b32 v11, v10
    v_max_f32 v10, v10, v11
    v_sub_f32 v96, 0, v10
    v_sub_f32 v97, 0, v10
    v_sub_f32 v98, 0, v10
    v_sub_f32 v99, 0, v10
    v_sub_f32 v100, 0, v10
    v_sub_f32 v101, 0, v10
    v_sub_f32 v102, 0, v10
    v_sub_f32 v103, 0, v10
    v_sub_f32 v104, 0, v10
    v_sub_f32 v105, 0, v10
    v_sub_f32 v106, 0, v10
    v_sub_f32 v107, 0, v10
    v_sub_f32 v108, 0, v10
    v_sub_f32 v109, 0, v10
    v_sub_f32 v110, 0, v10
    v_sub_f32 v111, 0, v10
    s_waitcnt lgkmcnt(0)
    s_nop 0
    v_mfma_f32_32x32x16_bf16 v[32:47], v[20:23], v[12:15], v[96:111]
    v_max3_f32 v10, v48, v49, v50
    v_max3_f32 v10, v10, v51, v52
    v_max3_f32 v10, v10, v53, v54
    v_max3_f32 v10, v10, v55, v56
    v_max3_f32 v10, v10, v57, v58
    v_max3_f32 v10, v10, v59, v60
    v_max3_f32 v10, v10, v61, v62
    v_max_f32 v10, v10, v63
    v_mov_b32 v11, v10
    s_nop 1
    v_permlane32_swap_b32 v11, v10
    v_max_f32 v10, v10, v11
    v_sub_f32 v112, 0, v10
    v_sub_f32 v113, 0, v10
    v_sub_f32 v114, 0, v10
    v_sub_f32 v115, 0, v10
    v_sub_f32 v116, 0, v10
    v_sub_f32 v117, 0, v10
    v_sub_f32 v118, 0, v10
    v_sub_f32 v119, 0, v10
    v_sub_f32 v120, 0, v10
    v_sub_f32 v121, 0, v10
    v_sub_f32 v122, 0, v10
    v_sub_f32 v123, 0, v10
    v_sub_f32 v124, 0, v10
    v_sub_f32 v125, 0, v10
    v_sub_f32 v126, 0, v10
    v_sub_f32 v127, 0, v10
    v_exp_f32 v32, v32
    v_exp_f32 v33, v33
    ds_read_b128 v[28:31], v5 offset:512
    v_exp_f32 v34, v34
    v_exp_f32 v35, v35
    v_exp_f32 v36, v36
    v_exp_f32 v37, v37
    v_mfma_f32_32x32x16_bf16 v[48:63], v[20:23], v[16:19], v[112:127]
    ds_read_b128 v[20:23], v4 offset:2048
    s_waitcnt lgkmcnt(2)
    v_exp_f32 v38, v38
    v_exp_f32 v39, v39
    v_exp_f32 v40, v40
    v_exp_f32 v41, v41
    v_exp_f32 v42, v42
    v_smfmac_f32_32x32x32_bf16 v[64:79], v[24:27], v[32:39], v7
    s_waitcnt lgkmcnt(1)
    v_exp_f32 v43, v43
    v_exp_f32 v44, v44
    v_exp_f32 v45, v45
    v_exp_f32 v46, v46
    v_exp_f32 v47, v47
    v_exp_f32 v48, v48
    v_exp_f32 v49, v49
    v_smfmac_f32_32x32x32_bf16 v[64:79], v[28:31], v[40:47], v7
    s_waitcnt lgkmcnt(0)
    v_exp_f32 v50, v50
    v_exp_f32 v51, v51
    v_exp_f32 v52, v52
    v_exp_f32 v53, v53
    v_mfma_f32_32x32x16_bf16 v[32:47], v[20:23], v[12:15], v[96:111]
    v_exp_f32 v54, v54
    v_exp_f32 v55, v55
    v_exp_f32 v56, v56
    v_exp_f32 v57, v57
    v_exp_f32 v58, v58
    v_smfmac_f32_32x32x32_bf16 v[80:95], v[24:27], v[48:55], v7
    ds_read_b128 v[24:27], v5 offset:2048
    v_exp_f32 v59, v59
    v_exp_f32 v60, v60
    v_exp_f32 v61, v61
    v_exp_f32 v62, v62
    v_exp_f32 v63, v63
    v_exp_f32 v32, v32
    v_exp_f32 v33, v33
    v_smfmac_f32_32x32x32_bf16 v[80:95], v[28:31], v[56:63], v7
    ds_read_b128 v[28:31], v5 offset:2560
    v_exp_f32 v34, v34
    v_exp_f32 v35, v35
    v_exp_f32 v36, v36
    v_exp_f32 v37, v37
    v_mfma_f32_32x32x16_bf16 v[48:63], v[20:23], v[16:19], v[112:127]
    s_waitcnt lgkmcnt(1)
    v_exp_f32 v38, v38
    v_exp_f32 v39, v39
    v_exp_f32 v40, v40
    v_exp_f32 v41, v41
    v_exp_f32 v42, v42
    v_smfmac_f32_32x32x32_bf16 v[64:79], v[24:27], v[32:39], v7
    s_waitcnt lgkmcnt(0)
    v_exp_f32 v43, v43
    v_exp_f32 v44, v44
    v_exp_f32 v45, v45
    v_exp_f32 v46, v46
    v_exp_f32 v47, v47
    v_exp_f32 v48, v48
    v_exp_f32 v49, v49
    v_smfmac_f32_32x32x32_bf16 v[64:79], v[28:31], v[40:47], v7
    s_waitcnt lgkmcnt(0)
    v_exp_f32 v50, v50
    v_exp_f32 v51, v51
    v_exp_f32 v52, v52
    v_exp_f32 v53, v53
    v_exp_f32 v54, v54
    v_exp_f32 v55, v55
    v_exp_f32 v56, v56
    v_exp_f32 v57, v57
    v_exp_f32 v58, v58
    v_smfmac_f32_32x32x32_bf16 v[80:95], v[24:27], v[48:55], v7
    v_exp_f32 v59, v59
    v_exp_f32 v60, v60
    v_exp_f32 v61, v61
    v_exp_f32 v62, v62
    v_exp_f32 v63, v63
    v_and_b32 v8, 15, v0
    v_lshlrev_b32 v8, 4, v8
    v_lshrrev_b32 v9, 5, v0
    v_lshl_add_u32 v8, v9, 8, v8
    v_bfe_u32 v9, v0, 4, 1
    v_lshl_add_u32 v8, v9, 10, v8
    v_and_b32 v4, 0x3fff, v4
    v_and_b32 v5, 0x13fff, v5
    s_cmp_ge_u32 s16, 4
    s_cbranch_scc1 L_a_go
    s_barrier
    s_cmp_lt_u32 s16, 2
    s_cbranch_scc1 L_a_go
    s_or_b32 s31, s17, 1
    s_lshl_b32 s24, s18, 12
    s_lshl_b32 s25, s31, 7
    s_add_u32 s24, s24, s25
    s_add_u32 s24, s24, 15990912
    s_add_u32 s24, s24, s12
    s_addc_u32 s25, s13, 0
    s_mov_b32 s53, 200000
L_fw11:
    s_load_dword s86, s[24:25], 0 glc
    s_load_dword s87, s[24:25], 128 glc
    s_load_dword s88, s[24:25], 256 glc
    s_load_dword s89, s[24:25], 384 glc
    s_load_dword s90, s[24:25], 512 glc
    s_load_dword s91, s[24:25], 640 glc
    s_load_dword s92, s[24:25], 768 glc
    s_load_dword s93, s[24:25], 896 glc
    s_load_dword s94, s[24:25], 1024 glc
    s_load_dword s95, s[24:25], 1152 glc
    s_load_dword s96, s[24:25], 1280 glc
    s_load_dword s97, s[24:25], 1408 glc
    s_load_dword s98, s[24:25], 1536 glc
    s_load_dword s99, s[24:25], 1664 glc
    s_waitcnt lgkmcnt(0)
    s_xor_b32 s86, s86, s52
    s_xor_b32 s87, s87, s52
    s_or_b32 s86, s86, s87
    s_xor_b32 s88, s88, s52
    s_or_b32 s86, s86, s88
    s_xor_b32 s89, s89, s52
    s_or_b32 s86, s86, s89
    s_xor_b32 s90, s90, s52
    s_or_b32 s86, s86, s90
    s_xor_b32 s91, s91, s52
    s_or_b32 s86, s86, s91
    s_xor_b32 s92, s92, s52
    s_or_b32 s86, s86, s92
    s_xor_b32 s93, s93, s52
    s_or_b32 s86, s86, s93
    s_xor_b32 s94, s94, s52
    s_or_b32 s86, s86, s94
    s_xor_b32 s95, s95, s52
    s_or_b32 s86, s86, s95
    s_xor_b32 s96, s96, s52
    s_or_b32 s86, s86, s96
    s_xor_b32 s97, s97, s52
    s_or_b32 s86, s86, s97
    s_xor_b32 s98, s98, s52
    s_or_b32 s86, s86, s98
    s_xor_b32 s99, s99, s52
    s_or_b32 s86, s86, s99
    s_cbranch_scc0 L_fd12
    s_sub_u32 s53, s53, 1
    s_cbranch_scc1 L_fd12
    s_sleep 1
    s_branch L_fw11
L_fd12:
    s_add_u32 m0, s34, 16384
    s_nop 0
    buffer_load_dwordx4 v2, s[56:59], s33 offen offset:0 sc1 lds
    buffer_load_dwordx4 v2, s[56:59], s33 offen offset:1024 sc1 lds
    buffer_load_dwordx4 v2, s[56:59], s33 offen offset:2048 sc1 lds
    buffer_load_dwordx4 v2, s[56:59], s33 offen offset:3072 sc1 lds
    s_add_u32 m0, s34, 24576
    s_nop 0
    buffer_load_dwordx4 v3, s[56:59], s33 offen offset:0 sc1 lds
    buffer_load_dwordx4 v3, s[56:59], s33 offen offset:1024 sc1 lds
    buffer_load_dwordx4 v3, s[56:59], s33 offen offset:2048 sc1 lds
    buffer_load_dwordx4 v3, s[56:59], s33 offen offset:3072 sc1 lds
L_a_go:
    ds_read_b128 v[20:23], v4 offset:4096
    ds_read_b128 v[24:27], v5 offset:4096
    s_mov_b32 s19, 0
    s_waitcnt lgkmcnt(1)
    v_mfma_f32_32x32x16_bf16 v[32:47], v[20:23], v[12:15], v[96:111]
    s_nop 10
    s_branch L_att_mid
L_att_loop:
    v_exp_f32 v32, v32
    v_exp_f32 v33, v33
    v_smfmac_f32_32x32x32_bf16 v[80:95], v[28:31], v[56:63], v7
    ds_read_b128 v[28:31], v5 offset:512
    v_exp_f32 v34, v34
    v_exp_f32 v35, v35
    v_exp_f32 v36, v36
    v_exp_f32 v37, v37
    v_mfma_f32_32x32x16_bf16 v[48:63], v[20:23], v[16:19], v[112:127]
    ds_read_b128 v[20:23], v4 offset:2048
    s_waitcnt lgkmcnt(2)
    v_exp_f32 v38, v38
    v_exp_f32 v39, v39
    v_exp_f32 v40, v40
    v_exp_f32 v41, v41
    v_exp_f32 v42, v42
    v_smfmac_f32_32x32x32_bf16 v[64:79], v[24:27], v[32:39], v7
    s_waitcnt lgkmcnt(1)
    buffer_load_dwordx4 v3, s[56:59], s21 offen sc1 lds
    s_setprio 2
    v_exp_f32 v43, v43
    v_exp_f32 v44, v44
    v_exp_f32 v45, v45
    v_exp_f32 v46, v46
    v_exp_f32 v47, v47
    v_exp_f32 v48, v48
    v_exp_f32 v49, v49
    v_smfmac_f32_32x32x32_bf16 v[64:79], v[28:31], v[40:47], v7
    s_waitcnt lgkmcnt(0)
    v_exp_f32 v50, v50
    v_exp_f32 v51, v51
    v_exp_f32 v52, v52
    v_exp_f32 v53, v53
    v_mfma_f32_32x32x16_bf16 v[32:47], v[20:23], v[12:15], v[96:111]
    v_exp_f32 v54, v54
    v_exp_f32 v55, v55
    v_exp_f32 v56, v56
    v_exp_f32 v57, v57
    v_exp_f32 v58, v58
    v_smfmac_f32_32x32x32_bf16 v[80:95], v[24:27], v[48:55], v7
    ds_read_b128 v[24:27], v5 offset:2048
    v_exp_f32 v59, v59
    v_exp_f32 v60, v60
    v_exp_f32 v61, v61
    v_exp_f32 v62, v62
    v_exp_f32 v63, v63
    v_exp_f32 v32, v32
    v_exp_f32 v33, v33
    v_smfmac_f32_32x32x32_bf16 v[80:95], v[28:31], v[56:63], v7
    ds_read_b128 v[28:31], v5 offset:2560
    v_exp_f32 v34, v34
    v_exp_f32 v35, v35
    v_exp_f32 v36, v36
    v_exp_f32 v37, v37
    v_mfma_f32_32x32x16_bf16 v[48:63], v[20:23], v[16:19], v[112:127]
    ds_read_b128 v[20:23], v4 offset:4096
    s_waitcnt lgkmcnt(2)
    v_exp_f32 v38, v38
    v_exp_f32 v39, v39
    v_exp_f32 v40, v40
    v_exp_f32 v41, v41
    v_exp_f32 v42, v42
    v_smfmac_f32_32x32x32_bf16 v[64:79], v[24:27], v[32:39], v7
    s_waitcnt lgkmcnt(1)
    v_exp_f32 v43, v43
    v_exp_f32 v44, v44
    v_exp_f32 v45, v45
    v_exp_f32 v46, v46
    v_exp_f32 v47, v47
    v_exp_f32 v48, v48
    v_exp_f32 v49, v49
    v_smfmac_f32_32x32x32_bf16 v[64:79], v[28:31], v[40:47], v7
    s_waitcnt lgkmcnt(0)
    v_exp_f32 v50, v50
    v_exp_f32 v51, v51
    v_exp_f32 v52, v52
    v_exp_f32 v53, v53
    v_mfma_f32_32x32x16_bf16 v[32:47], v[20:23], v[12:15], v[96:111]
    v_exp_f32 v54, v54
    v_exp_f32 v55, v55
    v_exp_f32 v56, v56
    v_exp_f32 v57, v57
    v_exp_f32 v58, v58
    v_smfmac_f32_32x32x32_bf16 v[80:95], v[24:27], v[48:55], v7
    ds_read_b128 v[24:27], v5 offset:4096
    v_exp_f32 v59, v59
    v_exp_f32 v60, v60
    v_exp_f32 v61, v61
    v_exp_f32 v62, v62
    v_exp_f32 v63, v63
L_att_mid:
    v_exp_f32 v32, v32
    v_exp_f32 v33, v33
    v_smfmac_f32_32x32x32_bf16 v[80:95], v[28:31], v[56:63], v7
    ds_read_b128 v[28:31], v5 offset:4608
    v_exp_f32 v34, v34
    v_exp_f32 v35, v35
    v_exp_f32 v36, v36
    v_exp_f32 v37, v37
    v_mfma_f32_32x32x16_bf16 v[48:63], v[20:23], v[16:19], v[112:127]
    ds_read_b128 v[20:23], v4 offset:6144
    s_waitcnt lgkmcnt(2)
    v_exp_f32 v38, v38
    v_exp_f32 v39, v39
    v_exp_f32 v40, v40
    v_exp_f32 v41, v41
    v_exp_f32 v42, v42
    v_smfmac_f32_32x32x32_bf16 v[64:79], v[24:27], v[32:39], v7
    s_waitcnt lgkmcnt(1)
    v_exp_f32 v43, v43
    v_exp_f32 v44, v44
    v_exp_f32 v45, v45
    v_exp_f32 v46, v46
    v_exp_f32 v47, v47
    v_exp_f32 v48, v48
    v_exp_f32 v49, v49
    v_smfmac_f32_32x32x32_bf16 v[64:79], v[28:31], v[40:47], v7
    s_waitcnt lgkmcnt(0)
    v_exp_f32 v50, v50
    v_exp_f32 v51, v51
    v_exp_f32 v52, v52
    v_exp_f32 v53, v53
    v_mfma_f32_32x32x16_bf16 v[32:47], v[20:23], v[12:15], v[96:111]
    v_exp_f32 v54, v54
    v_exp_f32 v55, v55
    v_exp_f32 v56, v56
    v_exp_f32 v57, v57
    v_exp_f32 v58, v58
    v_smfmac_f32_32x32x32_bf16 v[80:95], v[24:27], v[48:55], v7
    ds_read_b128 v[24:27], v5 offset:6144
    s_setprio 1
    v_exp_f32 v59, v59
    v_exp_f32 v60, v60
    v_exp_f32 v61, v61
    v_exp_f32 v62, v62
    v_exp_f32 v63, v63
    v_exp_f32 v32, v32
    v_exp_f32 v33, v33
    v_smfmac_f32_32x32x32_bf16 v[80:95], v[28:31], v[56:63], v7
    ds_read_b128 v[28:31], v5 offset:6656
    s_cmp_lt_u32 s19, 6
    s_cselect_b32 s58, s58, 0
    v_exp_f32 v34, v34
    v_exp_f32 v35, v35
    v_exp_f32 v36, v36
    v_xor_b32 v4, 16384, v4
    v_xor_b32 v5, v6, v5
    v_exp_f32 v37, v37
    v_mfma_f32_32x32x16_bf16 v[48:63], v[20:23], v[16:19], v[112:127]
    s_waitcnt vmcnt(0) lgkmcnt(0)
    s_barrier
    s_setprio 3
    ds_read_b128 v[20:23], v4 offset:0
    s_waitcnt lgkmcnt(2)
    v_exp_f32 v38, v38
    v_exp_f32 v39, v39
    v_exp_f32 v40, v40
    v_exp_f32 v41, v41
    v_exp_f32 v42, v42
    v_smfmac_f32_32x32x32_bf16 v[64:79], v[24:27], v[32:39], v7
    s_waitcnt lgkmcnt(1)
    v_exp_f32 v43, v43
    v_exp_f32 v44, v44
    v_exp_f32 v45, v45
    v_exp_f32 v46, v46
    v_exp_f32 v47, v47
    v_exp_f32 v48, v48
    v_exp_f32 v49, v49
    v_smfmac_f32_32x32x32_bf16 v[64:79], v[28:31], v[40:47], v7
    s_waitcnt lgkmcnt(0)
    v_exp_f32 v50, v50
    v_exp_f32 v51, v51
    v_exp_f32 v52, v52
    v_exp_f32 v53, v53
    v_mfma_f32_32x32x16_bf16 v[32:47], v[20:23], v[12:15], v[96:111]
    v_exp_f32 v54, v54
    v_exp_f32 v55, v55
    v_exp_f32 v56, v56
    v_exp_f32 v57, v57
    v_exp_f32 v58, v58
    v_smfmac_f32_32x32x32_bf16 v[80:95], v[24:27], v[48:55], v7
    ds_read_b128 v[24:27], v5 offset:0
    s_xor_b32 s22, s22, 16384
    s_add_u32 s21, s21, 8192
    s_mov_b32 m0, s22
    s_bitset0_b32 s21, 16
    buffer_load_dwordx4 v2, s[56:59], s21 offen sc1 lds
    s_add_u32 m0, s22, 8192
    s_add_u32 s19, s19, 1
    s_cmp_lt_u32 s19, 8
    v_exp_f32 v59, v59
    v_exp_f32 v60, v60
    v_exp_f32 v61, v61
    v_exp_f32 v62, v62
    v_exp_f32 v63, v63
    s_cbranch_scc1 L_att_loop
    s_nop 0
    v_smfmac_f32_32x32x32_bf16 v[80:95], v[28:31], v[56:63], v7
    s_setprio 3
    s_mul_i32 s24, s16, 3072
    v_add_u32 v10, s24, v2
    s_xor_b32 s24, s16, 1
    s_mul_i32 s24, s24, 3072
    v_add_u32 v11, s24, v2
    s_waitcnt lgkmcnt(0)
    s_nop 4
    ds_write_b128 v10, v[80:83] offset:32768
    ds_write_b128 v10, v[84:87] offset:33792
    ds_write_b32 v10, v88 offset:34816
    s_waitcnt lgkmcnt(0)
    s_barrier
    ds_read_b32 v40, v11 offset:34816
    ds_read_b128 v[32:35], v11 offset:32768
    ds_read_b128 v[36:39], v11 offset:33792
    v_mov_b32 v10, 0x5d800000
    s_waitcnt lgkmcnt(2)
    v_add_f32 v72, v72, v40
    v_cmp_nlt_f32 vcc, v72, v10
    s_waitcnt lgkmcnt(0)
    v_add_f32 v64, v64, v32
    v_add_f32 v65, v65, v33
    v_add_f32 v66, v66, v34
    v_add_f32 v67, v67, v35
    v_add_f32 v68, v68, v36
    v_add_f32 v69, v69, v37
    v_add_f32 v70, v70, v38
    v_add_f32 v71, v71, v39
    s_cbranch_vccnz L_att_fb
L_att_fin:
    v_rcp_f32 v10, v72
    s_nop 0
    v_mul_f32 v64, v10, v64
    v_mul_f32 v65, v10, v65
    v_mul_f32 v66, v10, v66
    v_mul_f32 v67, v10, v67
    v_mul_f32 v68, v10, v68
    v_mul_f32 v69, v10, v69
    v_mul_f32 v70, v10, v70
    v_mul_f32 v71, v10, v71
    v_cvt_pk_bf16_f32 v48, v64, v65
    v_cvt_pk_bf16_f32 v49, v66, v67
    v_cvt_pk_bf16_f32 v50, v68, v69
    v_cvt_pk_bf16_f32 v51, v70, v71
    v_min_u32 v48, -2, v48
    v_min_u32 v49, -2, v49
    v_min_u32 v50, -2, v50
    v_min_u32 v51, -2, v51
    buffer_store_dwordx4 v[48:51], v8, s[12:15], s28 offen sc0 sc1
L_a_end:
    s_endpgm
L_att_fb:
    s_mov_b32 s21, s20
    s_mov_b32 s19, 0
    s_mov_b32 s26, 0x0000ffff
    s_mov_b32 s27, 0x0000ffff
    v_mov_b32 v10, 0xff800000
L_att_fb1:
    buffer_load_dwordx4 v[20:23], v2, s[12:15], s21 offen sc1
    s_waitcnt vmcnt(0)
    v_mfma_f32_32x32x16_bf16 v[32:47], v[20:23], v[12:15], 0
    s_nop 11
    v_max3_f32 v10, v10, v32, v33
    v_max3_f32 v10, v10, v34, v35
    v_max3_f32 v10, v10, v36, v37
    v_max3_f32 v10, v10, v38, v39
    v_max3_f32 v10, v10, v40, v41
    v_max3_f32 v10, v10, v42, v43
    v_max3_f32 v10, v10, v44, v45
    v_max3_f32 v10, v10, v46, v47
    s_add_u32 s21, s21, 1024
    s_add_u32 s19, s19, 1
    s_cmp_lt_u32 s19, 64
    s_cbranch_scc1 L_att_fb1
    v_mov_b32 v11, v10
    s_nop 1
    v_permlane32_swap_b32 v11, v10
    v_max_f32 v10, v10, v11
    v_sub_f32 v96, 0, v10
    v_sub_f32 v97, 0, v10
    v_sub_f32 v98, 0, v10
    v_sub_f32 v99, 0, v10
    v_sub_f32 v100, 0, v10
    v_sub_f32 v101, 0, v10
    v_sub_f32 v102, 0, v10
    v_sub_f32 v103, 0, v10
    v_sub_f32 v104, 0, v10
    v_sub_f32 v105, 0, v10
    v_sub_f32 v106, 0, v10
    v_sub_f32 v107, 0, v10
    v_sub_f32 v108, 0, v10
    v_sub_f32 v109, 0, v10
    v_sub_f32 v110, 0, v10
    v_sub_f32 v111, 0, v10
    v_mov_b32 v64, 0
    v_mov_b32 v65, 0
    v_mov_b32 v66, 0
    v_mov_b32 v67, 0
    v_mov_b32 v68, 0
    v_mov_b32 v69, 0
    v_mov_b32 v70, 0
    v_mov_b32 v71, 0
    v_mov_b32 v72, 0
    v_mov_b32 v73, 0
    v_mov_b32 v74, 0
    v_mov_b32 v75, 0
    v_mov_b32 v76, 0
    v_mov_b32 v77, 0
    v_mov_b32 v78, 0
    v_mov_b32 v79, 0
    s_sub_u32 s21, s21, 65536
    s_mov_b32 s19, 0
    v_and_b32 v5, 0x1ff, v5
L_att_fb2:
    s_add_u32 s24, s21, 65536
    buffer_load_dwordx4 v[20:23], v2, s[12:15], s21 offen sc1
    s_mov_b64 exec, s[26:27]
    buffer_load_dwordx4 v[24:27], v5, s[12:15], s24 offen sc1
    buffer_load_dwordx4 v[28:31], v5, s[12:15], s24 offen offset:512 sc1
    s_mov_b64 exec, -1
    s_waitcnt vmcnt(0)
    v_mfma_f32_32x32x16_bf16 v[32:47], v[20:23], v[12:15], v[96:111]
    s_nop 11
    v_exp_f32 v32, v32
    v_exp_f32 v33, v33
    v_exp_f32 v34, v34
    v_exp_f32 v35, v35
    v_exp_f32 v36, v36
    v_exp_f32 v37, v37
    v_exp_f32 v38, v38
    v_exp_f32 v39, v39
    v_exp_f32 v40, v40
    v_exp_f32 v41, v41
    v_exp_f32 v42, v42
    v_exp_f32 v43, v43
    v_exp_f32 v44, v44
    v_exp_f32 v45, v45
    v_exp_f32 v46, v46
    v_exp_f32 v47, v47
    v_smfmac_f32_32x32x32_bf16 v[64:79], v[24:27], v[32:39], v7
    s_nop 0
    v_smfmac_f32_32x32x32_bf16 v[64:79], v[28:31], v[40:47], v7
    s_add_u32 s21, s21, 1024
    s_add_u32 s19, s19, 1
    s_cmp_lt_u32 s19, 64
    s_nop 7
    s_cbranch_scc1 L_att_fb2
    s_nop 7
    s_branch L_att_fin
L_role_f:
    s_load_dwordx2 s[56:57], s[0:1], 32
    s_load_dwordx2 s[28:29], s[0:1], 40
    s_load_dwordx2 s[44:45], s[0:1], 16
    s_load_dwordx2 s[48:49], s[0:1], 48
    s_load_dwordx2 s[36:37], s[0:1], 56
    s_setprio 3
    v_mov_b32 v17, 0
    s_lshl_b32 s24, s17, 6
    s_lshl_b32 s25, s55, 3
    s_add_u32 s24, s24, s25
    s_add_u32 s24, s24, s16
    s_xor_b32 s25, s54, 0
    s_lshl_b32 s25, s25, 11
    s_add_u32 s24, s24, s25
    s_lshl_b32 s3, s24, 11
    s_cmp_ge_u32 s3, 1835008
    s_cselect_b32 s24, 31, 15
    v_min_u32 v62, s24, v0
    v_lshlrev_b32 v62, 7, v62
    s_xor_b32 s32, s18, 8
    s_lshl_b32 s24, s18, 3
    s_add_u32 s24, s24, s16
    s_bfe_u32 s25, s24, 0x20002
    v_and_b32 v14, 1, v0
    v_mul_u32_u24 v14, 3, v14
    v_bfe_u32 v1, v0, 1, 1
    v_xor_b32 v14, v1, v14
    v_xor_b32 v14, s25, v14
    v_lshrrev_b32 v1, 2, v0
    v_lshlrev_b32 v1, 13, v1
    v_lshl_add_u32 v1, v14, 4, v1
    s_lshl_b32 s24, s24, 6
    v_add_u32 v2, s24, v1
    v_bfe_u32 v1, v0, 2, 2
    s_lshl_b32 s24, s16, 2
    v_add_u32 v1, s24, v1
    v_mul_u32_u24 v14, 3584, v1
    v_lshrrev_b32 v1, 4, v0
    v_lshl_add_u32 v14, v1, 6, v14
    v_and_b32 v1, 3, v0
    s_and_b32 s24, s16, 2
    v_xor_b32 v1, s24, v1
    v_lshl_add_u32 v14, v1, 4, v14
    s_lshl_b32 s24, s32, 8
    v_add_u32 v3, s24, v14
    s_lshl_b32 s27, s16, 10
    s_lshl_b32 s21, s17, 17
    s_add_u32 s21, s21, 4194304
    s_and_b32 s25, s16, 1
    s_lshl_b32 s25, s25, 12
    v_bfe_u32 v14, v0, 4, 1
    v_mul_u32_u24 v15, 3, v14
    v_lshrrev_b32 v1, 5, v0
    v_xor_b32 v15, v15, v1
    v_bfe_u32 v1, v0, 2, 2
    v_xor_b32 v15, v15, v1
    v_and_b32 v4, 15, v0
    v_lshlrev_b32 v4, 6, v4
    v_lshl_add_u32 v4, v15, 4, v4
    v_add_u32 v4, s25, v4
    v_lshlrev_b32 v1, 6, v1
    v_lshl_add_u32 v1, v14, 5, v1
    v_and_b32 v14, 3, v0
    v_lshl_add_u32 v1, v14, 3, v1
    v_mov_b32 v56, v1
    v_lshrrev_b32 v14, 4, v0
    v_lshl_add_u32 v1, v14, 11, v1
    s_lshr_b32 s24, s16, 1
    s_lshl_b32 s24, s24, 8
    s_add_u32 s24, s24, 8192
    v_add_u32 v5, s24, v1
    v_xor_b32 v6, 32, v5
    s_waitcnt lgkmcnt(0)
    s_mov_b32 s58, 1835008
    s_mov_b32 s59, 0x00020000
    s_mov_b32 s30, 1835008
    s_mov_b32 s31, 0x00020000
    s_mov_b32 s46, 524288
    s_mov_b32 s47, 0x00020000
    s_mov_b32 s50, 1835008
    s_mov_b32 s51, 0x00020000
    s_mov_b32 s38, 2097152
    s_mov_b32 s39, 0x00020000
    s_waitcnt vmcnt(0)
    v_lshlrev_b32 v24, 16, v20
    v_and_b32 v25, 0xffff0000, v20
    v_lshlrev_b32 v26, 16, v21
    v_and_b32 v27, 0xffff0000, v21
    v_lshlrev_b32 v28, 16, v22
    v_and_b32 v29, 0xffff0000, v22
    v_lshlrev_b32 v30, 16, v23
    v_and_b32 v31, 0xffff0000, v23
    v_add_f32 v12, v24, v25
    v_add_f32 v12, v12, v26
    v_add_f32 v12, v12, v27
    v_add_f32 v12, v12, v28
    v_add_f32 v12, v12, v29
    v_add_f32 v12, v12, v30
    v_add_f32 v12, v12, v31
    s_nop 1
    v_add_f32_dpp v12, v12, v12 quad_perm:[1,0,3,2] row_mask:0xf bank_mask:0xf
    s_nop 1
    v_add_f32_dpp v12, v12, v12 quad_perm:[2,3,0,1] row_mask:0xf bank_mask:0xf
    s_nop 1
    v_add_f32_dpp v12, v12, v12 row_half_mirror row_mask:0xf bank_mask:0xf
    s_nop 1
    v_add_f32_dpp v12, v12, v12 row_mirror row_mask:0xf bank_mask:0xf
    v_mov_b32 v15, v12
    s_nop 1
    v_permlane16_swap_b32 v15, v12
    v_add_f32 v12, v12, v15
    v_mov_b32 v15, v12
    s_nop 1
    v_permlane32_swap_b32 v15, v12
    v_add_f32 v12, v12, v15
    v_mul_f32 v12, 0x3b000000, v12
    v_mov_b32 v13, 0
    v_sub_f32 v14, v24, v12
    v_fmac_f32 v13, v14, v14
    v_sub_f32 v14, v25, v12
    v_fmac_f32 v13, v14, v14
    v_sub_f32 v14, v26, v12
    v_fmac_f32 v13, v14, v14
    v_sub_f32 v14, v27, v12
    v_fmac_f32 v13, v14, v14
    v_sub_f32 v14, v28, v12
    v_fmac_f32 v13, v14, v14
    v_sub_f32 v14, v29, v12
    v_fmac_f32 v13, v14, v14
    v_sub_f32 v14, v30, v12
    v_fmac_f32 v13, v14, v14
    v_sub_f32 v14, v31, v12
    v_fmac_f32 v13, v14, v14
    s_nop 1
    v_add_f32_dpp v13, v13, v13 quad_perm:[1,0,3,2] row_mask:0xf bank_mask:0xf
    s_nop 1
    v_add_f32_dpp v13, v13, v13 quad_perm:[2,3,0,1] row_mask:0xf bank_mask:0xf
    s_nop 1
    v_add_f32_dpp v13, v13, v13 row_half_mirror row_mask:0xf bank_mask:0xf
    s_nop 1
    v_add_f32_dpp v13, v13, v13 row_mirror row_mask:0xf bank_mask:0xf
    v_mov_b32 v15, v13
    s_nop 1
    v_permlane16_swap_b32 v15, v13
    v_add_f32 v13, v13, v15
    v_mov_b32 v15, v13
    s_nop 1
    v_permlane32_swap_b32 v15, v13
    v_add_f32 v13, v13, v15
    s_load_dword s52, s[40:41], 0
    v_mul_f32 v13, 0x3b000000, v13
    v_cvt_pk_bf16_f32 v14, v12, v13
    v_lshlrev_b32 v12, 16, v14
    v_and_b32 v13, 0xffff0000, v14
    v_add_f32 v13, 0x3727c5ac, v13
    v_cvt_pk_bf16_f32 v14, v13, v13
    v_lshlrev_b32 v14, 16, v14
    v_sqrt_f32 v14, v14
    s_nop 0
    v_cvt_pk_bf16_f32 v14, v14, v14
    v_lshlrev_b32 v14, 16, v14
    v_rcp_f32 v13, v14
    v_cvt_pk_bf16_f32 v32, v12, v14
    v_sub_f32 v24, v24, v12
    v_sub_f32 v25, v25, v12
    v_sub_f32 v26, v26, v12
    v_sub_f32 v27, v27, v12
    v_sub_f32 v28, v28, v12
    v_sub_f32 v29, v29, v12
    v_sub_f32 v30, v30, v12
    v_sub_f32 v31, v31, v12
    v_cvt_pk_bf16_f32 v20, v24, v25
    v_lshlrev_b32 v24, 16, v20
    v_and_b32 v25, 0xffff0000, v20
    v_mul_f32 v24, v13, v24
    v_mul_f32 v25, v13, v25
    v_cvt_pk_bf16_f32 v20, v24, v25
    v_cvt_pk_bf16_f32 v21, v26, v27
    v_lshlrev_b32 v26, 16, v21
    v_and_b32 v27, 0xffff0000, v21
    v_mul_f32 v26, v13, v26
    v_mul_f32 v27, v13, v27
    v_cvt_pk_bf16_f32 v21, v26, v27
    v_cvt_pk_bf16_f32 v22, v28, v29
    v_lshlrev_b32 v28, 16, v22
    v_and_b32 v29, 0xffff0000, v22
    v_mul_f32 v28, v13, v28
    v_mul_f32 v29, v13, v29
    v_cvt_pk_bf16_f32 v22, v28, v29
    v_cvt_pk_bf16_f32 v23, v30, v31
    v_lshlrev_b32 v30, 16, v23
    v_and_b32 v31, 0xffff0000, v23
    v_mul_f32 v30, v13, v30
    v_mul_f32 v31, v13, v31
    v_cvt_pk_bf16_f32 v23, v30, v31
    s_setprio 0
    buffer_store_dwordx4 v[20:23], v2, s[12:15], s21 offen sc0 sc1
    s_waitcnt lgkmcnt(0)
    v_mov_b32 v16, s52
    s_mov_b32 s53, 200000
L_np13:
    v_readfirstlane_b32 s52, v16
    s_nop 0
    s_cmp_lg_u32 s52, 0
    s_cbranch_scc1 L_nd14
    s_sub_u32 s53, s53, 1
    s_cbranch_scc1 L_nd14
    s_sleep 2
    buffer_load_dword v16, off, s[40:43], 0 sc0 sc1
    s_waitcnt vmcnt(0)
    s_branch L_np13
L_nd14:
    v_mov_b32 v33, s52
    s_lshr_b32 s24, s20, 7
    s_add_u32 s24, s24, 15859712
    s_mov_b64 exec, 1
    buffer_store_dwordx2 v[32:33], off, s[12:15], s24 sc0 sc1
    s_mov_b64 exec, -1
    v_mov_b32 v34, 0
    v_mov_b32 v35, 0
    v_mov_b32 v36, 0
    v_mov_b32 v37, 0
    v_mov_b32 v38, 0
    v_mov_b32 v39, 0
    v_mov_b32 v40, 0
    v_mov_b32 v41, 0
    v_mov_b32 v42, 0
    v_mov_b32 v43, 0
    v_mov_b32 v44, 0
    v_mov_b32 v45, 0
    v_mov_b32 v46, 0
    v_mov_b32 v47, 0
    v_mov_b32 v48, 0
    v_mov_b32 v49, 0
    v_mov_b32 v50, 0
    v_mov_b32 v51, 0
    v_mov_b32 v52, 0
    v_mov_b32 v53, 0
    v_mov_b32 v54, 0
    v_mov_b32 v55, 0
    v_mov_b32 v64, 0
    v_mov_b32 v65, 0
    v_mov_b32 v66, 0
    v_mov_b32 v67, 0
    v_mov_b32 v68, 0
    v_mov_b32 v69, 0
    v_mov_b32 v70, 0
    v_mov_b32 v71, 0
    v_mov_b32 v72, 0
    v_mov_b32 v73, 0
    v_mov_b32 v74, 0
    v_mov_b32 v75, 0
    v_mov_b32 v76, 0
    v_mov_b32 v77, 0
    v_mov_b32 v78, 0
    v_mov_b32 v79, 0
    v_mov_b32 v80, 0
    v_mov_b32 v81, 0
    v_mov_b32 v82, 0
    v_mov_b32 v83, 0
    v_mov_b32 v84, 0
    v_mov_b32 v85, 0
    v_mov_b32 v86, 0
    v_mov_b32 v87, 0
    v_mov_b32 v88, 0
    v_mov_b32 v89, 0
    v_mov_b32 v90, 0
    v_mov_b32 v91, 0
    v_mov_b32 v92, 0
    v_mov_b32 v93, 0
    v_mov_b32 v94, 0
    v_mov_b32 v95, 0
    v_mov_b32 v96, 0
    v_mov_b32 v97, 0
    v_mov_b32 v98, 0
    v_mov_b32 v99, 0
    v_mov_b32 v100, 0
    v_mov_b32 v101, 0
    v_mov_b32 v102, 0
    v_mov_b32 v103, 0
    v_mov_b32 v104, 0
    v_mov_b32 v105, 0
    v_mov_b32 v106, 0
    v_mov_b32 v107, 0
    v_mov_b32 v108, 0
    v_mov_b32 v109, 0
    v_mov_b32 v110, 0
    v_mov_b32 v111, 0
    v_mov_b32 v112, 0
    v_mov_b32 v113, 0
    v_mov_b32 v114, 0
    v_mov_b32 v115, 0
    v_mov_b32 v116, 0
    v_mov_b32 v117, 0
    v_mov_b32 v118, 0
    v_mov_b32 v119, 0
    v_mov_b32 v120, 0
    v_mov_b32 v121, 0
    v_mov_b32 v122, 0
    v_mov_b32 v123, 0
    v_mov_b32 v124, 0
    v_mov_b32 v125, 0
    v_mov_b32 v126, 0
    v_mov_b32 v127, 0
    v_mov_b32 v32, 0
    v_mov_b32 v33, 0
    s_waitcnt vmcnt(0)
    s_barrier
    s_cmp_lg_u32 s16, 0
    s_cbranch_scc1 L_f_nopub
    s_lshl_b32 s24, s17, 11
    s_lshl_b32 s25, s18, 7
    s_add_u32 s24, s24, s25
    s_add_u32 s24, s24, 15728640
    v_mov_b32 v14, s52
    v_mul_u32_u24 v15, 128, v0
    s_mov_b64 exec, 1
    buffer_store_dword v14, v15, s[12:15], s24 offen sc0 sc1
    s_mov_b64 exec, -1
L_f_nopub:
    s_lshr_b32 s19, s18, 1
    v_lshrrev_b32 v14, 5, v0
    v_lshlrev_b32 v14, 2, v14
    v_bfe_u32 v15, v0, 2, 2
    v_add_u32 v14, v14, v15
    v_lshlrev_b32 v14, 10, v14
    v_bfe_u32 v15, v0, 4, 1
    v_lshl_add_u32 v14, v15, 6, v14
    v_lshrrev_b32 v15, 4, v0
    v_and_b32 v15, 2, v15
    v_xor_b32 v15, v15, v0
    v_and_b32 v15, 3, v15
    v_lshl_add_u32 v14, v15, 4, v14
    s_lshl_b32 s24, s19, 7
    v_add_u32 v7, s24, v14
    s_lshl_b32 s34, s16, 14
    s_lshl_b32 s35, s16, 11
    s_lshr_b32 s24, s16, 2
    s_lshl_b32 s25, s17, 2
    s_add_u32 s24, s24, s25
    s_and_b32 s25, s18, 1
    s_lshl_b32 s25, s25, 1
    s_add_u32 s24, s24, s25
    s_mul_i32 s33, s24, 72
    s_and_b32 s25, s16, 3
    s_add_u32 s33, s33, s25
    s_lshl_b32 s33, s33, 11
    s_add_u32 s33, s33, 6291456
    v_and_b32 v14, 15, v0
    s_lshl_b32 s24, s24, 5
    v_add_u32 v14, s24, v14
    v_lshlrev_b32 v14, 10, v14
    v_lshrrev_b32 v15, 4, v0
    v_lshl_add_u32 v14, v15, 3, v14
    s_lshl_b32 s24, s19, 7
    s_lshl_b32 s25, s25, 5
    s_add_u32 s24, s24, s25
    v_add_u32 v10, s24, v14
    s_movk_i32 s24, 16384
    buffer_load_dwordx2 v[20:21], v10, s[4:7], 0 offen
    buffer_load_dwordx2 v[22:23], v10, s[4:7], s24 offen
    v_and_b32 v59, 1, v15
    v_mul_u32_u24 v59, 16376, v59
    v_add_u32 v59, v59, v10
    s_lshl_b32 s24, s17, 1
    s_and_b32 s25, s18, 1
    s_add_u32 s24, s24, s25
    s_lshl_b32 s24, s24, 3
    s_add_u32 s24, s24, s16
    s_lshl_b32 s24, s24, 13
    s_lshl_b32 s25, s19, 7
    s_add_u32 s24, s24, s25
    v_lshrrev_b32 v59, 3, v0
    v_and_b32 v60, 7, v0
    v_xor_b32 v61, v59, v60
    v_lshlrev_b32 v61, 4, v61
    v_lshl_add_u32 v61, v59, 7, v61
    v_lshlrev_b32 v59, 10, v59
    v_lshl_add_u32 v59, v60, 4, v59
    v_add_u32 v59, s24, v59
    s_lshl_b32 s24, s16, 10
    v_add_u32 v61, s24, v61
    s_and_b32 s24, s16, 3
    s_lshl_b32 s24, s24, 1
    v_lshrrev_b32 v1, 5, v0
    v_add_u32 v1, s24, v1
    v_xor_b32 v1, v1, v60
    v_lshlrev_b32 v1, 4, v1
    v_and_b32 v60, 31, v0
    v_lshl_add_u32 v60, v60, 7, v1
    s_and_b32 s24, s16, 4
    s_lshl_b32 s24, s24, 10
    v_add_u32 v60, s24, v60
    v_lshl_add_u32 v14, v15, 9, v56
    s_and_b32 s24, s16, 2
    s_lshl_b32 s24, s24, 7
    s_and_b32 s25, s16, 1
    s_lshl_b32 s25, s25, 5
    s_add_u32 s24, s24, s25
    v_xor_b32 v14, s24, v14
    s_and_b32 s25, s16, 3
    s_lshl_b32 s25, s25, 12
    v_add_u32 v8, s25, v14
    v_xor_b32 v9, 32, v8
    v_xor_b32 v57, 256, v8
    v_xor_b32 v58, 288, v8
    s_mul_i32 s24, s16, 6144
    s_add_u32 s24, s24, 32768
    v_add_u32 v11, s24, v18
    s_xor_b32 s24, s16, 1
    s_mul_i32 s24, s24, 6144
    s_add_u32 s24, s24, 32768
    v_add_u32 v12, s24, v18
    s_xor_b32 s24, s16, 2
    s_mul_i32 s24, s24, 6144
    s_add_u32 s24, s24, 32768
    v_add_u32 v13, s24, v18
    s_xor_b32 s24, s16, 3
    s_mul_i32 s24, s24, 6144
    s_add_u32 s24, s24, 32768
    v_add_u32 v19, s24, v18
    s_lshl_b32 s24, s17, 6
    s_lshl_b32 s25, s55, 3
    s_add_u32 s24, s24, s25
    s_add_u32 s24, s24, s16
    s_xor_b32 s25, s54, 0
    s_lshl_b32 s25, s25, 11
    s_add_u32 s24, s24, s25
    v_min_u32 v1, 27, v0
    s_lshr_b32 s24, s24, 1
    s_mul_i32 s24, s24, 3584
    v_lshlrev_b32 v1, 7, v1
    s_bitcmp1_b32 s16, 0
    s_cbranch_scc1 L_tu15
    buffer_load_dword v63, v1, s[56:59], s24 offen
    s_branch L_td16
L_tu15:
    buffer_load_dword v63, v1, s[28:31], s24 offen
L_td16:
    s_add_u32 s21, s21, s27
    s_mov_b32 s22, 0
    s_cmp_ge_u32 s32, 14
    s_cbranch_scc1 L_f_idle
    s_cmp_lg_u32 s16, 0
    s_cbranch_scc1 L_f_now1
    s_lshl_b32 s24, s17, 11
    s_add_u32 s24, s24, 15728640
    s_add_u32 s24, s24, s12
    s_addc_u32 s25, s13, 0
    s_mov_b32 s53, 200000
L_fw17:
    s_load_dword s86, s[24:25], 0 glc
    s_load_dword s87, s[24:25], 128 glc
    s_load_dword s88, s[24:25], 256 glc
    s_load_dword s89, s[24:25], 384 glc
    s_load_dword s90, s[24:25], 512 glc
    s_load_dword s91, s[24:25], 640 glc
    s_load_dword s92, s[24:25], 768 glc
    s_load_dword s93, s[24:25], 896 glc
    s_load_dword s94, s[24:25], 1024 glc
    s_load_dword s95, s[24:25], 1152 glc
    s_load_dword s96, s[24:25], 1280 glc
    s_load_dword s97, s[24:25], 1408 glc
    s_load_dword s98, s[24:25], 1536 glc
    s_load_dword s99, s[24:25], 1664 glc
    s_load_dword s100, s[24:25], 1792 glc
    s_load_dword s101, s[24:25], 1920 glc
    s_waitcnt lgkmcnt(0)
    s_xor_b32 s86, s86, s52
    s_xor_b32 s87, s87, s52
    s_or_b32 s86, s86, s87
    s_xor_b32 s88, s88, s52
    s_or_b32 s86, s86, s88
    s_xor_b32 s89, s89, s52
    s_or_b32 s86, s86, s89
    s_xor_b32 s90, s90, s52
    s_or_b32 s86, s86, s90
    s_xor_b32 s91, s91, s52
    s_or_b32 s86, s86, s91
    s_xor_b32 s92, s92, s52
    s_or_b32 s86, s86, s92
    s_xor_b32 s93, s93, s52
    s_or_b32 s86, s86, s93
    s_xor_b32 s94, s94, s52
    s_or_b32 s86, s86, s94
    s_xor_b32 s95, s95, s52
    s_or_b32 s86, s86, s95
    s_xor_b32 s96, s96, s52
    s_or_b32 s86, s86, s96
    s_xor_b32 s97, s97, s52
    s_or_b32 s86, s86, s97
    s_xor_b32 s98, s98, s52
    s_or_b32 s86, s86, s98
    s_xor_b32 s99, s99, s52
    s_or_b32 s86, s86, s99
    s_xor_b32 s100, s100, s52
    s_or_b32 s86, s86, s100
    s_xor_b32 s101, s101, s52
    s_or_b32 s86, s86, s101
    s_cbranch_scc0 L_fd18
    s_sub_u32 s53, s53, 1
    s_cbranch_scc1 L_fd18
    s_sleep 1
    s_branch L_fw17
L_fd18:
L_f_now1:
    s_barrier
    s_add_u32 m0, s27, 0
    s_nop 0
    buffer_load_dwordx4 v18, s[12:15], s21 offen sc1 lds
    s_add_u32 s21, s21, 8192
    s_add_u32 m0, s27, 8192
    s_nop 0
    buffer_load_dwordx4 v3, s[56:59], s22 offen lds
    s_add_u32 m0, s27, 16384
    s_nop 0
    buffer_load_dwordx4 v3, s[28:31], s22 offen lds
    s_add_u32 s22, s22, 114688
    s_add_u32 m0, s27, 24576
    s_nop 0
    buffer_load_dwordx4 v18, s[12:15], s21 offen sc1 lds
    s_add_u32 s21, s21, 8192
    s_add_u32 m0, s27, 32768
    s_nop 0
    buffer_load_dwordx4 v3, s[56:59], s22 offen lds
    s_add_u32 m0, s27, 40960
    s_nop 0
    buffer_load_dwordx4 v3, s[28:31], s22 offen lds
    s_add_u32 s22, s22, 114688
    s_setprio 0
    s_mov_b32 s19, 4
L_f_gu_loop:
    s_waitcnt vmcnt(3) lgkmcnt(0)
    s_barrier
    v_mfma_f32_16x16x32_bf16 v[96:99], v[40:43], v[32:35], v[96:99]
    ds_read_b128 v[24:27], v4 offset:0
    ds_read_b128 v[28:31], v4 offset:1024
    v_mfma_f32_16x16x32_bf16 v[112:115], v[40:43], v[36:39], v[112:115]
    ds_read_b64_tr_b16 v[40:41], v5 offset:0
    ds_read_b64_tr_b16 v[42:43], v5 offset:1024
    v_mfma_f32_16x16x32_bf16 v[100:103], v[44:47], v[32:35], v[100:103]
    s_add_u32 m0, s27, 49152
    s_nop 0
    buffer_load_dwordx4 v18, s[12:15], s21 offen sc1 lds
    s_add_u32 s21, s21, 8192
    v_mfma_f32_16x16x32_bf16 v[116:119], v[44:47], v[36:39], v[116:119]
    ds_read_b64_tr_b16 v[44:45], v6 offset:0
    ds_read_b64_tr_b16 v[46:47], v6 offset:1024
    v_mfma_f32_16x16x32_bf16 v[104:107], v[48:51], v[32:35], v[104:107]
    v_mfma_f32_16x16x32_bf16 v[120:123], v[48:51], v[36:39], v[120:123]
    ds_read_b64_tr_b16 v[48:49], v5 offset:8192
    ds_read_b64_tr_b16 v[50:51], v5 offset:9216
    v_mfma_f32_16x16x32_bf16 v[108:111], v[52:55], v[32:35], v[108:111]
    s_add_u32 m0, s27, 57344
    s_nop 0
    buffer_load_dwordx4 v3, s[56:59], s22 offen lds
    v_mfma_f32_16x16x32_bf16 v[124:127], v[52:55], v[36:39], v[124:127]
    ds_read_b64_tr_b16 v[52:53], v6 offset:8192
    ds_read_b64_tr_b16 v[54:55], v6 offset:9216
    s_waitcnt lgkmcnt(6)
    v_mfma_f32_16x16x32_bf16 v[64:67], v[40:43], v[24:27], v[64:67]
    ds_read_b128 v[32:35], v4 offset:2048
    v_mfma_f32_16x16x32_bf16 v[80:83], v[40:43], v[28:31], v[80:83]
    ds_read_b128 v[36:39], v4 offset:3072
    s_waitcnt lgkmcnt(6)
    v_mfma_f32_16x16x32_bf16 v[68:71], v[44:47], v[24:27], v[68:71]
    v_mfma_f32_16x16x32_bf16 v[84:87], v[44:47], v[28:31], v[84:87]
    s_add_u32 m0, s27, 65536
    s_nop 0
    buffer_load_dwordx4 v3, s[28:31], s22 offen lds
    s_add_u32 s22, s22, 114688
    s_waitcnt lgkmcnt(4)
    v_mfma_f32_16x16x32_bf16 v[72:75], v[48:51], v[24:27], v[72:75]
    v_mfma_f32_16x16x32_bf16 v[88:91], v[48:51], v[28:31], v[88:91]
    s_waitcnt lgkmcnt(2)
    v_mfma_f32_16x16x32_bf16 v[76:79], v[52:55], v[24:27], v[76:79]
    v_mfma_f32_16x16x32_bf16 v[92:95], v[52:55], v[28:31], v[92:95]
    s_waitcnt vmcnt(3) lgkmcnt(0)
    s_barrier
    v_mfma_f32_16x16x32_bf16 v[96:99], v[40:43], v[32:35], v[96:99]
    ds_read_b128 v[24:27], v4 offset:24576
    ds_read_b128 v[28:31], v4 offset:25600
    v_mfma_f32_16x16x32_bf16 v[112:115], v[40:43], v[36:39], v[112:115]
    ds_read_b64_tr_b16 v[40:41], v5 offset:24576
    ds_read_b64_tr_b16 v[42:43], v5 offset:25600
    v_mfma_f32_16x16x32_bf16 v[100:103], v[44:47], v[32:35], v[100:103]
    s_add_u32 m0, s27, 0
    s_nop 0
    buffer_load_dwordx4 v18, s[12:15], s21 offen sc1 lds
    s_add_u32 s21, s21, 8192
    v_mfma_f32_16x16x32_bf16 v[116:119], v[44:47], v[36:39], v[116:119]
    ds_read_b64_tr_b16 v[44:45], v6 offset:24576
    ds_read_b64_tr_b16 v[46:47], v6 offset:25600
    v_mfma_f32_16x16x32_bf16 v[104:107], v[48:51], v[32:35], v[104:107]
    v_mfma_f32_16x16x32_bf16 v[120:123], v[48:51], v[36:39], v[120:123]
    ds_read_b64_tr_b16 v[48:49], v5 offset:32768
    ds_read_b64_tr_b16 v[50:51], v5 offset:33792
    v_mfma_f32_16x16x32_bf16 v[108:111], v[52:55], v[32:35], v[108:111]
    s_add_u32 m0, s27, 8192
    s_nop 0
    buffer_load_dwordx4 v3, s[56:59], s22 offen lds
    v_mfma_f32_16x16x32_bf16 v[124:127], v[52:55], v[36:39], v[124:127]
    ds_read_b64_tr_b16 v[52:53], v6 offset:32768
    ds_read_b64_tr_b16 v[54:55], v6 offset:33792
    s_waitcnt lgkmcnt(6)
    v_mfma_f32_16x16x32_bf16 v[64:67], v[40:43], v[24:27], v[64:67]
    ds_read_b128 v[32:35], v4 offset:26624
    v_mfma_f32_16x16x32_bf16 v[80:83], v[40:43], v[28:31], v[80:83]
    ds_read_b128 v[36:39], v4 offset:27648
    s_waitcnt lgkmcnt(6)
    v_mfma_f32_16x16x32_bf16 v[68:71], v[44:47], v[24:27], v[68:71]
    v_mfma_f32_16x16x32_bf16 v[84:87], v[44:47], v[28:31], v[84:87]
    s_add_u32 m0, s27, 16384
    s_nop 0
    buffer_load_dwordx4 v3, s[28:31], s22 offen lds
    s_add_u32 s22, s22, 114688
    s_waitcnt lgkmcnt(4)
    v_mfma_f32_16x16x32_bf16 v[72:75], v[48:51], v[24:27], v[72:75]
    v_mfma_f32_16x16x32_bf16 v[88:91], v[48:51], v[28:31], v[88:91]
    s_waitcnt lgkmcnt(2)
    v_mfma_f32_16x16x32_bf16 v[76:79], v[52:55], v[24:27], v[76:79]
    v_mfma_f32_16x16x32_bf16 v[92:95], v[52:55], v[28:31], v[92:95]
    s_waitcnt vmcnt(3) lgkmcnt(0)
    s_barrier
    v_mfma_f32_16x16x32_bf16 v[96:99], v[40:43], v[32:35], v[96:99]
    ds_read_b128 v[24:27], v4 offset:49152
    ds_read_b128 v[28:31], v4 offset:50176
    v_mfma_f32_16x16x32_bf16 v[112:115], v[40:43], v[36:39], v[112:115]
    ds_read_b64_tr_b16 v[40:41], v5 offset:49152
    ds_read_b64_tr_b16 v[42:43], v5 offset:50176
    v_mfma_f32_16x16x32_bf16 v[100:103], v[44:47], v[32:35], v[100:103]
    s_add_u32 m0, s27, 24576
    s_nop 0
    buffer_load_dwordx4 v18, s[12:15], s21 offen sc1 lds
    s_add_u32 s21, s21, 8192
    v_mfma_f32_16x16x32_bf16 v[116:119], v[44:47], v[36:39], v[116:119]
    ds_read_b64_tr_b16 v[44:45], v6 offset:49152
    ds_read_b64_tr_b16 v[46:47], v6 offset:50176
    v_mfma_f32_16x16x32_bf16 v[104:107], v[48:51], v[32:35], v[104:107]
    v_mfma_f32_16x16x32_bf16 v[120:123], v[48:51], v[36:39], v[120:123]
    ds_read_b64_tr_b16 v[48:49], v5 offset:57344
    ds_read_b64_tr_b16 v[50:51], v5 offset:58368
    v_mfma_f32_16x16x32_bf16 v[108:111], v[52:55], v[32:35], v[108:111]
    s_add_u32 m0, s27, 32768
    s_nop 0
    buffer_load_dwordx4 v3, s[56:59], s22 offen lds
    v_mfma_f32_16x16x32_bf16 v[124:127], v[52:55], v[36:39], v[124:127]
    ds_read_b64_tr_b16 v[52:53], v6 offset:57344
    ds_read_b64_tr_b16 v[54:55], v6 offset:58368
    s_waitcnt lgkmcnt(6)
    v_mfma_f32_16x16x32_bf16 v[64:67], v[40:43], v[24:27], v[64:67]
    ds_read_b128 v[32:35], v4 offset:51200
    v_mfma_f32_16x16x32_bf16 v[80:83], v[40:43], v[28:31], v[80:83]
    ds_read_b128 v[36:39], v4 offset:52224
    s_waitcnt lgkmcnt(6)
    v_mfma_f32_16x16x32_bf16 v[68:71], v[44:47], v[24:27], v[68:71]
    v_mfma_f32_16x16x32_bf16 v[84:87], v[44:47], v[28:31], v[84:87]
    s_add_u32 m0, s27, 40960
    s_nop 0
    buffer_load_dwordx4 v3, s[28:31], s22 offen lds
    s_add_u32 s22, s22, 114688
    s_waitcnt lgkmcnt(4)
    v_mfma_f32_16x16x32_bf16 v[72:75], v[48:51], v[24:27], v[72:75]
    v_mfma_f32_16x16x32_bf16 v[88:91], v[48:51], v[28:31], v[88:91]
    s_waitcnt lgkmcnt(2)
    v_mfma_f32_16x16x32_bf16 v[76:79], v[52:55], v[24:27], v[76:79]
    v_mfma_f32_16x16x32_bf16 v[92:95], v[52:55], v[28:31], v[92:95]
    s_sub_u32 s19, s19, 1
    s_cmp_lg_u32 s19, 0
    s_cbranch_scc1 L_f_gu_loop
    s_waitcnt vmcnt(3) lgkmcnt(0)
    s_barrier
    v_mfma_f32_16x16x32_bf16 v[96:99], v[40:43], v[32:35], v[96:99]
    ds_read_b128 v[24:27], v4 offset:0
    ds_read_b128 v[28:31], v4 offset:1024
    v_mfma_f32_16x16x32_bf16 v[112:115], v[40:43], v[36:39], v[112:115]
    ds_read_b64_tr_b16 v[40:41], v5 offset:0
    ds_read_b64_tr_b16 v[42:43], v5 offset:1024
    v_mfma_f32_16x16x32_bf16 v[100:103], v[44:47], v[32:35], v[100:103]
    s_add_u32 m0, s27, 49152
    s_nop 0
    buffer_load_dwordx4 v18, s[12:15], s21 offen sc1 lds
    s_add_u32 s21, s21, 8192
    v_mfma_f32_16x16x32_bf16 v[116:119], v[44:47], v[36:39], v[116:119]
    ds_read_b64_tr_b16 v[44:45], v6 offset:0
    ds_read_b64_tr_b16 v[46:47], v6 offset:1024
    v_mfma_f32_16x16x32_bf16 v[104:107], v[48:51], v[32:35], v[104:107]
    v_mfma_f32_16x16x32_bf16 v[120:123], v[48:51], v[36:39], v[120:123]
    ds_read_b64_tr_b16 v[48:49], v5 offset:8192
    ds_read_b64_tr_b16 v[50:51], v5 offset:9216
    v_mfma_f32_16x16x32_bf16 v[108:111], v[52:55], v[32:35], v[108:111]
    s_add_u32 m0, s27, 57344
    s_nop 0
    buffer_load_dwordx4 v3, s[56:59], s22 offen lds
    v_mfma_f32_16x16x32_bf16 v[124:127], v[52:55], v[36:39], v[124:127]
    ds_read_b64_tr_b16 v[52:53], v6 offset:8192
    ds_read_b64_tr_b16 v[54:55], v6 offset:9216
    s_waitcnt lgkmcnt(6)
    v_mfma_f32_16x16x32_bf16 v[64:67], v[40:43], v[24:27], v[64:67]
    ds_read_b128 v[32:35], v4 offset:2048
    v_mfma_f32_16x16x32_bf16 v[80:83], v[40:43], v[28:31], v[80:83]
    ds_read_b128 v[36:39], v4 offset:3072
    s_waitcnt lgkmcnt(6)
    v_mfma_f32_16x16x32_bf16 v[68:71], v[44:47], v[24:27], v[68:71]
    v_mfma_f32_16x16x32_bf16 v[84:87], v[44:47], v[28:31], v[84:87]
    s_add_u32 m0, s27, 65536
    s_nop 0
    buffer_load_dwordx4 v3, s[28:31], s22 offen lds
    s_add_u32 s22, s22, 114688
    s_waitcnt lgkmcnt(4)
    v_mfma_f32_16x16x32_bf16 v[72:75], v[48:51], v[24:27], v[72:75]
    v_mfma_f32_16x16x32_bf16 v[88:91], v[48:51], v[28:31], v[88:91]
    s_waitcnt lgkmcnt(2)
    v_mfma_f32_16x16x32_bf16 v[76:79], v[52:55], v[24:27], v[76:79]
    v_mfma_f32_16x16x32_bf16 v[92:95], v[52:55], v[28:31], v[92:95]
    s_waitcnt vmcnt(3) lgkmcnt(0)
    s_barrier
    v_mfma_f32_16x16x32_bf16 v[96:99], v[40:43], v[32:35], v[96:99]
    ds_read_b128 v[24:27], v4 offset:24576
    ds_read_b128 v[28:31], v4 offset:25600
    v_mfma_f32_16x16x32_bf16 v[112:115], v[40:43], v[36:39], v[112:115]
    ds_read_b64_tr_b16 v[40:41], v5 offset:24576
    ds_read_b64_tr_b16 v[42:43], v5 offset:25600
    v_mfma_f32_16x16x32_bf16 v[100:103], v[44:47], v[32:35], v[100:103]
    s_add_u32 m0, s27, 0
    s_nop 0
    buffer_load_dwordx4 v18, s[12:15], s21 offen sc1 lds
    s_add_u32 s21, s21, 8192
    v_mfma_f32_16x16x32_bf16 v[116:119], v[44:47], v[36:39], v[116:119]
    ds_read_b64_tr_b16 v[44:45], v6 offset:24576
    ds_read_b64_tr_b16 v[46:47], v6 offset:25600
    v_mfma_f32_16x16x32_bf16 v[104:107], v[48:51], v[32:35], v[104:107]
    v_mfma_f32_16x16x32_bf16 v[120:123], v[48:51], v[36:39], v[120:123]
    ds_read_b64_tr_b16 v[48:49], v5 offset:32768
    ds_read_b64_tr_b16 v[50:51], v5 offset:33792
    v_mfma_f32_16x16x32_bf16 v[108:111], v[52:55], v[32:35], v[108:111]
    s_add_u32 m0, s27, 8192
    s_nop 0
    buffer_load_dwordx4 v3, s[56:59], s22 offen lds
    v_mfma_f32_16x16x32_bf16 v[124:127], v[52:55], v[36:39], v[124:127]
    ds_read_b64_tr_b16 v[52:53], v6 offset:32768
    ds_read_b64_tr_b16 v[54:55], v6 offset:33792
    s_waitcnt lgkmcnt(6)
    v_mfma_f32_16x16x32_bf16 v[64:67], v[40:43], v[24:27], v[64:67]
    ds_read_b128 v[32:35], v4 offset:26624
    v_mfma_f32_16x16x32_bf16 v[80:83], v[40:43], v[28:31], v[80:83]
    ds_read_b128 v[36:39], v4 offset:27648
    s_waitcnt lgkmcnt(6)
    v_mfma_f32_16x16x32_bf16 v[68:71], v[44:47], v[24:27], v[68:71]
    v_mfma_f32_16x16x32_bf16 v[84:87], v[44:47], v[28:31], v[84:87]
    s_add_u32 m0, s27, 16384
    s_nop 0
    buffer_load_dwordx4 v3, s[28:31], s22 offen lds
    s_add_u32 s22, s22, 114688
    s_waitcnt lgkmcnt(4)
    v_mfma_f32_16x16x32_bf16 v[72:75], v[48:51], v[24:27], v[72:75]
    v_mfma_f32_16x16x32_bf16 v[88:91], v[48:51], v[28:31], v[88:91]
    s_waitcnt lgkmcnt(2)
    v_mfma_f32_16x16x32_bf16 v[76:79], v[52:55], v[24:27], v[76:79]
    v_mfma_f32_16x16x32_bf16 v[92:95], v[52:55], v[28:31], v[92:95]
    s_cmp_ge_u32 s3, 1835008
    s_cbranch_scc1 L_tu19
    buffer_load_dword v63, v62, s[48:51], s3 offen
    s_branch L_td20
L_tu19:
    s_sub_u32 s24, s3, 1835008
    s_lshl_b32 s24, s24, 1
    buffer_load_dword v63, v62, s[44:47], s24 offen
L_td20:
    s_waitcnt vmcnt(4) lgkmcnt(0)
    s_barrier
    v_mfma_f32_16x16x32_bf16 v[96:99], v[40:43], v[32:35], v[96:99]
    ds_read_b128 v[24:27], v4 offset:49152
    ds_read_b128 v[28:31], v4 offset:50176
    v_mfma_f32_16x16x32_bf16 v[112:115], v[40:43], v[36:39], v[112:115]
    ds_read_b64_tr_b16 v[40:41], v5 offset:49152
    ds_read_b64_tr_b16 v[42:43], v5 offset:50176
    v_mfma_f32_16x16x32_bf16 v[100:103], v[44:47], v[32:35], v[100:103]
    v_mfma_f32_16x16x32_bf16 v[116:119], v[44:47], v[36:39], v[116:119]
    ds_read_b64_tr_b16 v[44:45], v6 offset:49152
    ds_read_b64_tr_b16 v[46:47], v6 offset:50176
    v_mfma_f32_16x16x32_bf16 v[104:107], v[48:51], v[32:35], v[104:107]
    v_mfma_f32_16x16x32_bf16 v[120:123], v[48:51], v[36:39], v[120:123]
    ds_read_b64_tr_b16 v[48:49], v5 offset:57344
    ds_read_b64_tr_b16 v[50:51], v5 offset:58368
    v_mfma_f32_16x16x32_bf16 v[108:111], v[52:55], v[32:35], v[108:111]
    v_mfma_f32_16x16x32_bf16 v[124:127], v[52:55], v[36:39], v[124:127]
    ds_read_b64_tr_b16 v[52:53], v6 offset:57344
    ds_read_b64_tr_b16 v[54:55], v6 offset:58368
    s_waitcnt lgkmcnt(6)
    v_mfma_f32_16x16x32_bf16 v[64:67], v[40:43], v[24:27], v[64:67]
    ds_read_b128 v[32:35], v4 offset:51200
    v_mfma_f32_16x16x32_bf16 v[80:83], v[40:43], v[28:31], v[80:83]
    ds_read_b128 v[36:39], v4 offset:52224
    s_waitcnt lgkmcnt(6)
    v_mfma_f32_16x16x32_bf16 v[68:71], v[44:47], v[24:27], v[68:71]
    v_mfma_f32_16x16x32_bf16 v[84:87], v[44:47], v[28:31], v[84:87]
    s_waitcnt lgkmcnt(4)
    v_mfma_f32_16x16x32_bf16 v[72:75], v[48:51], v[24:27], v[72:75]
    v_mfma_f32_16x16x32_bf16 v[88:91], v[48:51], v[28:31], v[88:91]
    s_waitcnt lgkmcnt(2)
    v_mfma_f32_16x16x32_bf16 v[76:79], v[52:55], v[24:27], v[76:79]
    v_mfma_f32_16x16x32_bf16 v[92:95], v[52:55], v[28:31], v[92:95]
    s_waitcnt vmcnt(1) lgkmcnt(0)
    s_barrier
    v_mfma_f32_16x16x32_bf16 v[96:99], v[40:43], v[32:35], v[96:99]
    ds_read_b128 v[24:27], v4 offset:0
    ds_read_b128 v[28:31], v4 offset:1024
    v_mfma_f32_16x16x32_bf16 v[112:115], v[40:43], v[36:39], v[112:115]
    ds_read_b64_tr_b16 v[40:41], v5 offset:0
    ds_read_b64_tr_b16 v[42:43], v5 offset:1024
    v_mfma_f32_16x16x32_bf16 v[100:103], v[44:47], v[32:35], v[100:103]
    v_mfma_f32_16x16x32_bf16 v[116:119], v[44:47], v[36:39], v[116:119]
    ds_read_b64_tr_b16 v[44:45], v6 offset:0
    ds_read_b64_tr_b16 v[46:47], v6 offset:1024
    v_mfma_f32_16x16x32_bf16 v[104:107], v[48:51], v[32:35], v[104:107]
    v_mfma_f32_16x16x32_bf16 v[120:123], v[48:51], v[36:39], v[120:123]
    ds_read_b64_tr_b16 v[48:49], v5 offset:8192
    ds_read_b64_tr_b16 v[50:51], v5 offset:9216
    v_mfma_f32_16x16x32_bf16 v[108:111], v[52:55], v[32:35], v[108:111]
    v_mfma_f32_16x16x32_bf16 v[124:127], v[52:55], v[36:39], v[124:127]
    ds_read_b64_tr_b16 v[52:53], v6 offset:8192
    ds_read_b64_tr_b16 v[54:55], v6 offset:9216
    s_waitcnt lgkmcnt(6)
    v_mfma_f32_16x16x32_bf16 v[64:67], v[40:43], v[24:27], v[64:67]
    ds_read_b128 v[32:35], v4 offset:2048
    v_mfma_f32_16x16x32_bf16 v[80:83], v[40:43], v[28:31], v[80:83]
    ds_read_b128 v[36:39], v4 offset:3072
    s_waitcnt lgkmcnt(6)
    v_mfma_f32_16x16x32_bf16 v[68:71], v[44:47], v[24:27], v[68:71]
    v_mfma_f32_16x16x32_bf16 v[84:87], v[44:47], v[28:31], v[84:87]
    s_waitcnt lgkmcnt(4)
    v_mfma_f32_16x16x32_bf16 v[72:75], v[48:51], v[24:27], v[72:75]
    v_mfma_f32_16x16x32_bf16 v[88:91], v[48:51], v[28:31], v[88:91]
    s_waitcnt lgkmcnt(2)
    v_mfma_f32_16x16x32_bf16 v[76:79], v[52:55], v[24:27], v[76:79]
    v_mfma_f32_16x16x32_bf16 v[92:95], v[52:55], v[28:31], v[92:95]
    s_waitcnt lgkmcnt(0)
    v_mfma_f32_16x16x32_bf16 v[96:99], v[40:43], v[32:35], v[96:99]
    v_mfma_f32_16x16x32_bf16 v[112:115], v[40:43], v[36:39], v[112:115]
    v_mfma_f32_16x16x32_bf16 v[100:103], v[44:47], v[32:35], v[100:103]
    v_mfma_f32_16x16x32_bf16 v[116:119], v[44:47], v[36:39], v[116:119]
    v_mfma_f32_16x16x32_bf16 v[104:107], v[48:51], v[32:35], v[104:107]
    v_mfma_f32_16x16x32_bf16 v[120:123], v[48:51], v[36:39], v[120:123]
    v_mfma_f32_16x16x32_bf16 v[108:111], v[52:55], v[32:35], v[108:111]
    v_mfma_f32_16x16x32_bf16 v[124:127], v[52:55], v[36:39], v[124:127]
    s_setprio 3
    s_and_b32 s24, s16, 1
    s_lshl_b32 s24, s24, 1
    s_lshl_b32 s25, s17, 2
    s_add_u32 s24, s24, s25
    s_mul_i32 s24, s24, 144
    s_lshl_b32 s25, s32, 3
    s_add_u32 s24, s24, s25
    s_and_b32 s25, s16, 6
    s_add_u32 s24, s24, s25
    s_lshl_b32 s24, s24, 10
    s_add_u32 s24, s24, 6324224
    v_max_f32 v64, 0, v64
    v_mul_f32 v64, v72, v64
    v_max_f32 v65, 0, v65
    v_mul_f32 v65, v73, v65
    v_max_f32 v66, 0, v66
    v_mul_f32 v66, v74, v66
    v_max_f32 v67, 0, v67
    v_mul_f32 v67, v75, v67
    v_max_f32 v68, 0, v68
    v_mul_f32 v68, v76, v68
    v_max_f32 v69, 0, v69
    v_mul_f32 v69, v77, v69
    v_max_f32 v70, 0, v70
    v_mul_f32 v70, v78, v70
    v_max_f32 v71, 0, v71
    v_mul_f32 v71, v79, v71
    v_cvt_pk_bf16_f32 v72, v64, v65
    v_cvt_pk_bf16_f32 v73, v66, v67
    v_cvt_pk_bf16_f32 v74, v68, v69
    v_cvt_pk_bf16_f32 v75, v70, v71
    buffer_store_dwordx4 v[72:75], v18, s[12:15], s24 offen offset:0 sc0 sc1
    v_max_f32 v80, 0, v80
    v_mul_f32 v80, v88, v80
    v_max_f32 v81, 0, v81
    v_mul_f32 v81, v89, v81
    v_max_f32 v82, 0, v82
    v_mul_f32 v82, v90, v82
    v_max_f32 v83, 0, v83
    v_mul_f32 v83, v91, v83
    v_max_f32 v84, 0, v84
    v_mul_f32 v84, v92, v84
    v_max_f32 v85, 0, v85
    v_mul_f32 v85, v93, v85
    v_max_f32 v86, 0, v86
    v_mul_f32 v86, v94, v86
    v_max_f32 v87, 0, v87
    v_mul_f32 v87, v95, v87
    v_cvt_pk_bf16_f32 v88, v80, v81
    v_cvt_pk_bf16_f32 v89, v82, v83
    v_cvt_pk_bf16_f32 v90, v84, v85
    v_cvt_pk_bf16_f32 v91, v86, v87
    buffer_store_dwordx4 v[88:91], v18, s[12:15], s24 offen offset:1024 sc0 sc1
    s_add_u32 s24, s24, 147456
    v_max_f32 v96, 0, v96
    v_mul_f32 v96, v104, v96
    v_max_f32 v97, 0, v97
    v_mul_f32 v97, v105, v97
    v_max_f32 v98, 0, v98
    v_mul_f32 v98, v106, v98
    v_max_f32 v99, 0, v99
    v_mul_f32 v99, v107, v99
    v_max_f32 v100, 0, v100
    v_mul_f32 v100, v108, v100
    v_max_f32 v101, 0, v101
    v_mul_f32 v101, v109, v101
    v_max_f32 v102, 0, v102
    v_mul_f32 v102, v110, v102
    v_max_f32 v103, 0, v103
    v_mul_f32 v103, v111, v103
    v_cvt_pk_bf16_f32 v104, v96, v97
    v_cvt_pk_bf16_f32 v105, v98, v99
    v_cvt_pk_bf16_f32 v106, v100, v101
    v_cvt_pk_bf16_f32 v107, v102, v103
    buffer_store_dwordx4 v[104:107], v18, s[12:15], s24 offen offset:0 sc0 sc1
    v_max_f32 v112, 0, v112
    v_mul_f32 v112, v120, v112
    v_max_f32 v113, 0, v113
    v_mul_f32 v113, v121, v113
    v_max_f32 v114, 0, v114
    v_mul_f32 v114, v122, v114
    v_max_f32 v115, 0, v115
    v_mul_f32 v115, v123, v115
    v_max_f32 v116, 0, v116
    v_mul_f32 v116, v124, v116
    v_max_f32 v117, 0, v117
    v_mul_f32 v117, v125, v117
    v_max_f32 v118, 0, v118
    v_mul_f32 v118, v126, v118
    v_max_f32 v119, 0, v119
    v_mul_f32 v119, v127, v119
    v_cvt_pk_bf16_f32 v120, v112, v113
    v_cvt_pk_bf16_f32 v121, v114, v115
    v_cvt_pk_bf16_f32 v122, v116, v117
    v_cvt_pk_bf16_f32 v123, v118, v119
    buffer_store_dwordx4 v[120:123], v18, s[12:15], s24 offen offset:1024 sc0 sc1
    s_waitcnt vmcnt(0)
    s_barrier
    s_cmp_lg_u32 s16, 0
    s_cbranch_scc1 L_f_nogu
    s_lshl_b32 s24, s17, 12
    s_lshl_b32 s25, s32, 7
    s_add_u32 s24, s24, s25
    s_add_u32 s24, s24, 16056320
    v_mov_b32 v14, s52
    v_mul_u32_u24 v15, 1792, v0
    s_mov_b64 exec, 3
    buffer_store_dword v14, v15, s[12:15], s24 offen sc0 sc1
    s_mov_b64 exec, -1
    s_branch L_f_nogu
L_f_idle:
    s_setprio 3
    s_and_b32 s19, s16, 6
    s_cmp_lg_u32 s19, 2
    s_cbranch_scc1 L_sc21
    s_and_b32 s19, s16, 1
    s_xor_b32 s19, s17, s19
    s_lshl_b32 s24, s19, 7
    s_add_u32 s24, s24, 15990784
    s_add_u32 s24, s24, s12
    s_addc_u32 s25, s13, 0
    s_mov_b32 s53, 200000
L_fw22:
    s_load_dword s86, s[24:25], 0 glc
    s_load_dword s87, s[24:25], 4096 glc
    s_load_dword s88, s[24:25], 8192 glc
    s_load_dword s89, s[24:25], 12288 glc
    s_load_dword s90, s[24:25], 16384 glc
    s_load_dword s91, s[24:25], 20480 glc
    s_load_dword s92, s[24:25], 24576 glc
    s_load_dword s93, s[24:25], 28672 glc
    s_load_dword s94, s[24:25], 32768 glc
    s_load_dword s95, s[24:25], 36864 glc
    s_load_dword s96, s[24:25], 40960 glc
    s_load_dword s97, s[24:25], 45056 glc
    s_load_dword s98, s[24:25], 49152 glc
    s_load_dword s99, s[24:25], 53248 glc
    s_load_dword s100, s[24:25], 57344 glc
    s_load_dword s101, s[24:25], 61440 glc
    s_waitcnt lgkmcnt(0)
    s_xor_b32 s86, s86, s52
    s_xor_b32 s87, s87, s52
    s_or_b32 s86, s86, s87
    s_xor_b32 s88, s88, s52
    s_or_b32 s86, s86, s88
    s_xor_b32 s89, s89, s52
    s_or_b32 s86, s86, s89
    s_xor_b32 s90, s90, s52
    s_or_b32 s86, s86, s90
    s_xor_b32 s91, s91, s52
    s_or_b32 s86, s86, s91
    s_xor_b32 s92, s92, s52
    s_or_b32 s86, s86, s92
    s_xor_b32 s93, s93, s52
    s_or_b32 s86, s86, s93
    s_xor_b32 s94, s94, s52
    s_or_b32 s86, s86, s94
    s_xor_b32 s95, s95, s52
    s_or_b32 s86, s86, s95
    s_xor_b32 s96, s96, s52
    s_or_b32 s86, s86, s96
    s_xor_b32 s97, s97, s52
    s_or_b32 s86, s86, s97
    s_xor_b32 s98, s98, s52
    s_or_b32 s86, s86, s98
    s_xor_b32 s99, s99, s52
    s_or_b32 s86, s86, s99
    s_xor_b32 s100, s100, s52
    s_or_b32 s86, s86, s100
    s_xor_b32 s101, s101, s52
    s_or_b32 s86, s86, s101
    s_cbranch_scc0 L_fd23
    s_sub_u32 s53, s53, 1
    s_cbranch_scc1 L_fd23
    s_sleep 4
    s_branch L_fw22
L_fd23:
L_sc21:
    s_barrier
    s_cmp_ge_u32 s3, 1835008
    s_cbranch_scc1 L_tu24
    buffer_load_dword v63, v62, s[48:51], s3 offen
    s_branch L_td25
L_tu24:
    s_sub_u32 s24, s3, 1835008
    s_lshl_b32 s24, s24, 1
    buffer_load_dword v63, v62, s[44:47], s24 offen
L_td25:
    s_min_u32 s32, s32, 13
    s_cmp_lg_u32 s16, 0
    s_cbranch_scc1 L_f_idle3
    s_lshl_b32 s24, s17, 12
    s_lshl_b32 s25, s32, 7
    s_add_u32 s24, s24, s25
    s_add_u32 s24, s24, 16056320
    s_add_u32 s24, s24, s12
    s_addc_u32 s25, s13, 0
    s_mov_b32 s53, 200000
L_fw26:
    s_load_dword s86, s[24:25], 0 glc
    s_waitcnt lgkmcnt(0)
    s_xor_b32 s86, s86, s52
    s_cbranch_scc0 L_fd27
    s_sub_u32 s53, s53, 1
    s_cbranch_scc1 L_fd27
    s_sleep 4
    s_branch L_fw26
L_fd27:
L_f_idle3:
    s_waitcnt vmcnt(0)
    s_barrier
L_f_nogu:
    s_lshr_b32 s21, s16, 1
    s_lshl_b32 s21, s21, 2
    s_and_b32 s24, s16, 1
    s_add_u32 s21, s21, s24
    s_lshl_b32 s21, s21, 13
    s_add_u32 m0, s35, 0
    s_add_u32 s24, s34, 0
    buffer_load_dwordx4 v7, s[48:51], s24 offen lds
    s_add_u32 m0, s35, 1024
    s_add_u32 s24, s34, 8192
    buffer_load_dwordx4 v7, s[48:51], s24 offen lds
    s_add_u32 m0, s35, 16384
    s_add_u32 s24, s34, 131072
    buffer_load_dwordx4 v7, s[48:51], s24 offen lds
    s_add_u32 m0, s35, 17408
    s_add_u32 s24, s34, 139264
    buffer_load_dwordx4 v7, s[48:51], s24 offen lds
    s_add_u32 m0, s35, 32768
    s_add_u32 s24, s34, 262144
    buffer_load_dwordx4 v7, s[48:51], s24 offen lds
    s_add_u32 m0, s35, 33792
    s_add_u32 s24, s34, 270336
    buffer_load_dwordx4 v7, s[48:51], s24 offen lds
    s_add_u32 m0, s35, 49152
    s_add_u32 s24, s34, 393216
    buffer_load_dwordx4 v7, s[48:51], s24 offen lds
    s_add_u32 m0, s35, 50176
    s_add_u32 s24, s34, 401408
    buffer_load_dwordx4 v7, s[48:51], s24 offen lds
    v_lshlrev_b32 v64, 16, v20
    v_and_b32 v65, 0xffff0000, v20
    v_lshlrev_b32 v66, 16, v21
    v_and_b32 v67, 0xffff0000, v21
    v_lshlrev_b32 v68, 16, v22
    v_and_b32 v69, 0xffff0000, v22
    v_lshlrev_b32 v70, 16, v23
    v_and_b32 v71, 0xffff0000, v23
    s_cmp_lg_u32 s16, 0
    s_cbranch_scc1 L_f_now2
    s_lshl_b32 s24, s17, 12
    s_lshl_b32 s25, s32, 7
    s_add_u32 s24, s24, s25
    s_add_u32 s24, s24, 16056448
    s_add_u32 s24, s24, s12
    s_addc_u32 s25, s13, 0
    s_mov_b32 s53, 200000
L_fw28:
    s_load_dword s86, s[24:25], 0 glc
    s_load_dword s87, s[24:25], 128 glc
    s_load_dword s88, s[24:25], 256 glc
    s_load_dword s89, s[24:25], 384 glc
    s_load_dword s90, s[24:25], 512 glc
    s_load_dword s91, s[24:25], 640 glc
    s_load_dword s92, s[24:25], 768 glc
    s_load_dword s93, s[24:25], 896 glc
    s_load_dword s94, s[24:25], 1024 glc
    s_load_dword s95, s[24:25], 1152 glc
    s_load_dword s96, s[24:25], 1280 glc
    s_load_dword s97, s[24:25], 1408 glc
    s_load_dword s98, s[24:25], 1536 glc
    s_waitcnt lgkmcnt(0)
    s_xor_b32 s86, s86, s52
    s_xor_b32 s87, s87, s52
    s_or_b32 s86, s86, s87
    s_xor_b32 s88, s88, s52
    s_or_b32 s86, s86, s88
    s_xor_b32 s89, s89, s52
    s_or_b32 s86, s86, s89
    s_xor_b32 s90, s90, s52
    s_or_b32 s86, s86, s90
    s_xor_b32 s91, s91, s52
    s_or_b32 s86, s86, s91
    s_xor_b32 s92, s92, s52
    s_or_b32 s86, s86, s92
    s_xor_b32 s93, s93, s52
    s_or_b32 s86, s86, s93
    s_xor_b32 s94, s94, s52
    s_or_b32 s86, s86, s94
    s_xor_b32 s95, s95, s52
    s_or_b32 s86, s86, s95
    s_xor_b32 s96, s96, s52
    s_or_b32 s86, s86, s96
    s_xor_b32 s97, s97, s52
    s_or_b32 s86, s86, s97
    s_xor_b32 s98, s98, s52
    s_or_b32 s86, s86, s98
    s_cbranch_scc0 L_fd29
    s_sub_u32 s53, s53, 1
    s_cbranch_scc1 L_fd29
    s_sleep 1
    s_branch L_fw28
L_fd29:
L_f_now2:
    s_and_b32 s19, s16, 6
    s_cmp_lg_u32 s19, 2
    s_cbranch_scc1 L_sc30
    s_and_b32 s19, s16, 1
    s_xor_b32 s19, s17, s19
    s_lshl_b32 s24, s19, 7
    s_add_u32 s24, s24, 15990784
    s_add_u32 s24, s24, s12
    s_addc_u32 s25, s13, 0
    s_mov_b32 s53, 200000
L_fw31:
    s_load_dword s86, s[24:25], 0 glc
    s_load_dword s87, s[24:25], 4096 glc
    s_load_dword s88, s[24:25], 8192 glc
    s_load_dword s89, s[24:25], 12288 glc
    s_load_dword s90, s[24:25], 16384 glc
    s_load_dword s91, s[24:25], 20480 glc
    s_load_dword s92, s[24:25], 24576 glc
    s_load_dword s93, s[24:25], 28672 glc
    s_load_dword s94, s[24:25], 32768 glc
    s_load_dword s95, s[24:25], 36864 glc
    s_load_dword s96, s[24:25], 40960 glc
    s_load_dword s97, s[24:25], 45056 glc
    s_load_dword s98, s[24:25], 49152 glc
    s_load_dword s99, s[24:25], 53248 glc
    s_load_dword s100, s[24:25], 57344 glc
    s_load_dword s101, s[24:25], 61440 glc
    s_waitcnt lgkmcnt(0)
    s_xor_b32 s86, s86, s52
    s_xor_b32 s87, s87, s52
    s_or_b32 s86, s86, s87
    s_xor_b32 s88, s88, s52
    s_or_b32 s86, s86, s88
    s_xor_b32 s89, s89, s52
    s_or_b32 s86, s86, s89
    s_xor_b32 s90, s90, s52
    s_or_b32 s86, s86, s90
    s_xor_b32 s91, s91, s52
    s_or_b32 s86, s86, s91
    s_xor_b32 s92, s92, s52
    s_or_b32 s86, s86, s92
    s_xor_b32 s93, s93, s52
    s_or_b32 s86, s86, s93
    s_xor_b32 s94, s94, s52
    s_or_b32 s86, s86, s94
    s_xor_b32 s95, s95, s52
    s_or_b32 s86, s86, s95
    s_xor_b32 s96, s96, s52
    s_or_b32 s86, s86, s96
    s_xor_b32 s97, s97, s52
    s_or_b32 s86, s86, s97
    s_xor_b32 s98, s98, s52
    s_or_b32 s86, s86, s98
    s_xor_b32 s99, s99, s52
    s_or_b32 s86, s86, s99
    s_xor_b32 s100, s100, s52
    s_or_b32 s86, s86, s100
    s_xor_b32 s101, s101, s52
    s_or_b32 s86, s86, s101
    s_cbranch_scc0 L_fd32
    s_sub_u32 s53, s53, 1
    s_cbranch_scc1 L_fd32
    s_sleep 4
    s_branch L_fw31
L_fd32:
L_sc30:
    s_waitcnt vmcnt(0)
    s_barrier
    s_add_u32 s24, s33, 32768
    buffer_load_dwordx4 v[24:27], v18, s[12:15], s24 offen sc1
    buffer_load_dwordx4 v[28:31], v18, s[12:15], s24 offen offset:1024 sc1
    s_add_u32 s24, s33, 40960
    buffer_load_dwordx4 v[32:35], v18, s[12:15], s24 offen sc1
    buffer_load_dwordx4 v[36:39], v18, s[12:15], s24 offen offset:1024 sc1
    s_add_u32 s24, s33, 49152
    buffer_load_dwordx4 v[40:43], v18, s[12:15], s24 offen sc1
    buffer_load_dwordx4 v[44:47], v18, s[12:15], s24 offen offset:1024 sc1
    s_add_u32 s24, s33, 57344
    buffer_load_dwordx4 v[48:51], v18, s[12:15], s24 offen sc1
    buffer_load_dwordx4 v[52:55], v18, s[12:15], s24 offen offset:1024 sc1
    s_setprio 0
    ds_read_b64_tr_b16 v[96:97], v8 offset:0
    ds_read_b64_tr_b16 v[98:99], v8 offset:2048
    ds_read_b64_tr_b16 v[100:101], v9 offset:0
    ds_read_b64_tr_b16 v[102:103], v9 offset:2048
    ds_read_b64_tr_b16 v[104:105], v57 offset:0
    ds_read_b64_tr_b16 v[106:107], v57 offset:2048
    ds_read_b64_tr_b16 v[108:109], v58 offset:0
    ds_read_b64_tr_b16 v[110:111], v58 offset:2048
    s_waitcnt vmcnt(6) lgkmcnt(0)
    s_barrier
    v_mfma_f32_16x16x32_bf16 v[64:67], v[96:99], v[24:27], v[64:67]
    v_mfma_f32_16x16x32_bf16 v[68:71], v[96:99], v[28:31], v[68:71]
    ds_read_b64_tr_b16 v[112:113], v8 offset:16384
    ds_read_b64_tr_b16 v[114:115], v8 offset:18432
    ds_read_b64_tr_b16 v[116:117], v9 offset:16384
    ds_read_b64_tr_b16 v[118:119], v9 offset:18432
    v_mfma_f32_16x16x32_bf16 v[72:75], v[100:103], v[24:27], 0
    v_mfma_f32_16x16x32_bf16 v[76:79], v[100:103], v[28:31], 0
    ds_read_b64_tr_b16 v[120:121], v57 offset:16384
    ds_read_b64_tr_b16 v[122:123], v57 offset:18432
    ds_read_b64_tr_b16 v[124:125], v58 offset:16384
    ds_read_b64_tr_b16 v[126:127], v58 offset:18432
    v_mfma_f32_16x16x32_bf16 v[80:83], v[104:107], v[24:27], 0
    v_mfma_f32_16x16x32_bf16 v[84:87], v[104:107], v[28:31], 0
    s_add_u32 m0, s35, 0
    s_add_u32 s24, s34, 524288
    buffer_load_dwordx4 v7, s[48:51], s24 offen lds
    s_add_u32 m0, s35, 1024
    s_add_u32 s24, s34, 532480
    buffer_load_dwordx4 v7, s[48:51], s24 offen lds
    v_mfma_f32_16x16x32_bf16 v[88:91], v[108:111], v[24:27], 0
    v_mfma_f32_16x16x32_bf16 v[92:95], v[108:111], v[28:31], 0
    s_add_u32 s24, s33, 65536
    buffer_load_dwordx4 v[24:27], v18, s[12:15], s24 offen sc1
    buffer_load_dwordx4 v[28:31], v18, s[12:15], s24 offen offset:1024 sc1
    s_waitcnt vmcnt(8) lgkmcnt(0)
    s_barrier
    v_mfma_f32_16x16x32_bf16 v[64:67], v[112:115], v[32:35], v[64:67]
    v_mfma_f32_16x16x32_bf16 v[68:71], v[112:115], v[36:39], v[68:71]
    ds_read_b64_tr_b16 v[96:97], v8 offset:32768
    ds_read_b64_tr_b16 v[98:99], v8 offset:34816
    ds_read_b64_tr_b16 v[100:101], v9 offset:32768
    ds_read_b64_tr_b16 v[102:103], v9 offset:34816
    v_mfma_f32_16x16x32_bf16 v[72:75], v[116:119], v[32:35], v[72:75]
    v_mfma_f32_16x16x32_bf16 v[76:79], v[116:119], v[36:39], v[76:79]
    ds_read_b64_tr_b16 v[104:105], v57 offset:32768
    ds_read_b64_tr_b16 v[106:107], v57 offset:34816
    ds_read_b64_tr_b16 v[108:109], v58 offset:32768
    ds_read_b64_tr_b16 v[110:111], v58 offset:34816
    v_mfma_f32_16x16x32_bf16 v[80:83], v[120:123], v[32:35], v[80:83]
    v_mfma_f32_16x16x32_bf16 v[84:87], v[120:123], v[36:39], v[84:87]
    s_add_u32 m0, s35, 16384
    s_add_u32 s24, s34, 655360
    buffer_load_dwordx4 v7, s[48:51], s24 offen lds
    s_add_u32 m0, s35, 17408
    s_add_u32 s24, s34, 663552
    buffer_load_dwordx4 v7, s[48:51], s24 offen lds
    v_mfma_f32_16x16x32_bf16 v[88:91], v[124:127], v[32:35], v[88:91]
    v_mfma_f32_16x16x32_bf16 v[92:95], v[124:127], v[36:39], v[92:95]
    s_add_u32 s24, s33, 73728
    buffer_load_dwordx4 v[32:35], v18, s[12:15], s24 offen sc1
    buffer_load_dwordx4 v[36:39], v18, s[12:15], s24 offen offset:1024 sc1
    s_waitcnt vmcnt(10) lgkmcnt(0)
    s_barrier
    v_mfma_f32_16x16x32_bf16 v[64:67], v[96:99], v[40:43], v[64:67]
    v_mfma_f32_16x16x32_bf16 v[68:71], v[96:99], v[44:47], v[68:71]
    ds_read_b64_tr_b16 v[112:113], v8 offset:49152
    ds_read_b64_tr_b16 v[114:115], v8 offset:51200
    ds_read_b64_tr_b16 v[116:117], v9 offset:49152
    ds_read_b64_tr_b16 v[118:119], v9 offset:51200
    v_mfma_f32_16x16x32_bf16 v[72:75], v[100:103], v[40:43], v[72:75]
    v_mfma_f32_16x16x32_bf16 v[76:79], v[100:103], v[44:47], v[76:79]
    ds_read_b64_tr_b16 v[120:121], v57 offset:49152
    ds_read_b64_tr_b16 v[122:123], v57 offset:51200
    ds_read_b64_tr_b16 v[124:125], v58 offset:49152
    ds_read_b64_tr_b16 v[126:127], v58 offset:51200
    v_mfma_f32_16x16x32_bf16 v[80:83], v[104:107], v[40:43], v[80:83]
    v_mfma_f32_16x16x32_bf16 v[84:87], v[104:107], v[44:47], v[84:87]
    s_add_u32 m0, s35, 32768
    s_add_u32 s24, s34, 786432
    buffer_load_dwordx4 v7, s[48:51], s24 offen lds
    s_add_u32 m0, s35, 33792
    s_add_u32 s24, s34, 794624
    buffer_load_dwordx4 v7, s[48:51], s24 offen lds
    v_mfma_f32_16x16x32_bf16 v[88:91], v[108:111], v[40:43], v[88:91]
    v_mfma_f32_16x16x32_bf16 v[92:95], v[108:111], v[44:47], v[92:95]
    s_add_u32 s24, s33, 81920
    buffer_load_dwordx4 v[40:43], v18, s[12:15], s24 offen sc1
    buffer_load_dwordx4 v[44:47], v18, s[12:15], s24 offen offset:1024 sc1
    s_waitcnt vmcnt(10) lgkmcnt(0)
    s_barrier
    v_mfma_f32_16x16x32_bf16 v[64:67], v[112:115], v[48:51], v[64:67]
    v_mfma_f32_16x16x32_bf16 v[68:71], v[112:115], v[52:55], v[68:71]
    ds_read_b64_tr_b16 v[96:97], v8 offset:0
    ds_read_b64_tr_b16 v[98:99], v8 offset:2048
    ds_read_b64_tr_b16 v[100:101], v9 offset:0
    ds_read_b64_tr_b16 v[102:103], v9 offset:2048
    v_mfma_f32_16x16x32_bf16 v[72:75], v[116:119], v[48:51], v[72:75]
    v_mfma_f32_16x16x32_bf16 v[76:79], v[116:119], v[52:55], v[76:79]
    ds_read_b64_tr_b16 v[104:105], v57 offset:0
    ds_read_b64_tr_b16 v[106:107], v57 offset:2048
    ds_read_b64_tr_b16 v[108:109], v58 offset:0
    ds_read_b64_tr_b16 v[110:111], v58 offset:2048
    v_mfma_f32_16x16x32_bf16 v[80:83], v[120:123], v[48:51], v[80:83]
    v_mfma_f32_16x16x32_bf16 v[84:87], v[120:123], v[52:55], v[84:87]
    s_add_u32 m0, s35, 49152
    s_add_u32 s24, s34, 917504
    buffer_load_dwordx4 v7, s[48:51], s24 offen lds
    s_add_u32 m0, s35, 50176
    s_add_u32 s24, s34, 925696
    buffer_load_dwordx4 v7, s[48:51], s24 offen lds
    v_mfma_f32_16x16x32_bf16 v[88:91], v[124:127], v[48:51], v[88:91]
    v_mfma_f32_16x16x32_bf16 v[92:95], v[124:127], v[52:55], v[92:95]
    s_add_u32 s24, s33, 90112
    buffer_load_dwordx4 v[48:51], v18, s[12:15], s24 offen sc1
    buffer_load_dwordx4 v[52:55], v18, s[12:15], s24 offen offset:1024 sc1
    s_waitcnt vmcnt(10) lgkmcnt(0)
    s_barrier
    v_mfma_f32_16x16x32_bf16 v[64:67], v[96:99], v[24:27], v[64:67]
    v_mfma_f32_16x16x32_bf16 v[68:71], v[96:99], v[28:31], v[68:71]
    ds_read_b64_tr_b16 v[112:113], v8 offset:16384
    ds_read_b64_tr_b16 v[114:115], v8 offset:18432
    ds_read_b64_tr_b16 v[116:117], v9 offset:16384
    ds_read_b64_tr_b16 v[118:119], v9 offset:18432
    v_mfma_f32_16x16x32_bf16 v[72:75], v[100:103], v[24:27], v[72:75]
    v_mfma_f32_16x16x32_bf16 v[76:79], v[100:103], v[28:31], v[76:79]
    ds_read_b64_tr_b16 v[120:121], v57 offset:16384
    ds_read_b64_tr_b16 v[122:123], v57 offset:18432
    ds_read_b64_tr_b16 v[124:125], v58 offset:16384
    ds_read_b64_tr_b16 v[126:127], v58 offset:18432
    v_mfma_f32_16x16x32_bf16 v[80:83], v[104:107], v[24:27], v[80:83]
    v_mfma_f32_16x16x32_bf16 v[84:87], v[104:107], v[28:31], v[84:87]
    s_add_u32 m0, s35, 0
    s_add_u32 s24, s34, 1048576
    buffer_load_dwordx4 v7, s[48:51], s24 offen lds
    s_add_u32 m0, s35, 1024
    s_add_u32 s24, s34, 1056768
    buffer_load_dwordx4 v7, s[48:51], s24 offen lds
    v_mfma_f32_16x16x32_bf16 v[88:91], v[108:111], v[24:27], v[88:91]
    v_mfma_f32_16x16x32_bf16 v[92:95], v[108:111], v[28:31], v[92:95]
    s_add_u32 s24, s33, 98304
    buffer_load_dwordx4 v[24:27], v18, s[12:15], s24 offen sc1
    buffer_load_dwordx4 v[28:31], v18, s[12:15], s24 offen offset:1024 sc1
    s_waitcnt vmcnt(10) lgkmcnt(0)
    s_barrier
    v_mfma_f32_16x16x32_bf16 v[64:67], v[112:115], v[32:35], v[64:67]
    v_mfma_f32_16x16x32_bf16 v[68:71], v[112:115], v[36:39], v[68:71]
    ds_read_b64_tr_b16 v[96:97], v8 offset:32768
    ds_read_b64_tr_b16 v[98:99], v8 offset:34816
    ds_read_b64_tr_b16 v[100:101], v9 offset:32768
    ds_read_b64_tr_b16 v[102:103], v9 offset:34816
    v_mfma_f32_16x16x32_bf16 v[72:75], v[116:119], v[32:35], v[72:75]
    v_mfma_f32_16x16x32_bf16 v[76:79], v[116:119], v[36:39], v[76:79]
    ds_read_b64_tr_b16 v[104:105], v57 offset:32768
    ds_read_b64_tr_b16 v[106:107], v57 offset:34816
    ds_read_b64_tr_b16 v[108:109], v58 offset:32768
    ds_read_b64_tr_b16 v[110:111], v58 offset:34816
    v_mfma_f32_16x16x32_bf16 v[80:83], v[120:123], v[32:35], v[80:83]
    v_mfma_f32_16x16x32_bf16 v[84:87], v[120:123], v[36:39], v[84:87]
    s_add_u32 m0, s35, 16384
    s_add_u32 s24, s34, 1179648
    buffer_load_dwordx4 v7, s[48:51], s24 offen lds
    s_add_u32 m0, s35, 17408
    s_add_u32 s24, s34, 1187840
    buffer_load_dwordx4 v7, s[48:51], s24 offen lds
    v_mfma_f32_16x16x32_bf16 v[88:91], v[124:127], v[32:35], v[88:91]
    v_mfma_f32_16x16x32_bf16 v[92:95], v[124:127], v[36:39], v[92:95]
    s_add_u32 s24, s33, 106496
    buffer_load_dwordx4 v[32:35], v18, s[12:15], s24 offen sc1
    buffer_load_dwordx4 v[36:39], v18, s[12:15], s24 offen offset:1024 sc1
    s_waitcnt vmcnt(10) lgkmcnt(0)
    s_barrier
    v_mfma_f32_16x16x32_bf16 v[64:67], v[96:99], v[40:43], v[64:67]
    v_mfma_f32_16x16x32_bf16 v[68:71], v[96:99], v[44:47], v[68:71]
    ds_read_b64_tr_b16 v[112:113], v8 offset:49152
    ds_read_b64_tr_b16 v[114:115], v8 offset:51200
    ds_read_b64_tr_b16 v[116:117], v9 offset:49152
    ds_read_b64_tr_b16 v[118:119], v9 offset:51200
    v_mfma_f32_16x16x32_bf16 v[72:75], v[100:103], v[40:43], v[72:75]
    v_mfma_f32_16x16x32_bf16 v[76:79], v[100:103], v[44:47], v[76:79]
    ds_read_b64_tr_b16 v[120:121], v57 offset:49152
    ds_read_b64_tr_b16 v[122:123], v57 offset:51200
    ds_read_b64_tr_b16 v[124:125], v58 offset:49152
    ds_read_b64_tr_b16 v[126:127], v58 offset:51200
    v_mfma_f32_16x16x32_bf16 v[80:83], v[104:107], v[40:43], v[80:83]
    v_mfma_f32_16x16x32_bf16 v[84:87], v[104:107], v[44:47], v[84:87]
    s_add_u32 m0, s35, 32768
    s_add_u32 s24, s34, 1310720
    buffer_load_dwordx4 v7, s[48:51], s24 offen lds
    s_add_u32 m0, s35, 33792
    s_add_u32 s24, s34, 1318912
    buffer_load_dwordx4 v7, s[48:51], s24 offen lds
    v_mfma_f32_16x16x32_bf16 v[88:91], v[108:111], v[40:43], v[88:91]
    v_mfma_f32_16x16x32_bf16 v[92:95], v[108:111], v[44:47], v[92:95]
    s_add_u32 s24, s33, 114688
    buffer_load_dwordx4 v[40:43], v18, s[12:15], s24 offen sc1
    buffer_load_dwordx4 v[44:47], v18, s[12:15], s24 offen offset:1024 sc1
    s_waitcnt vmcnt(10) lgkmcnt(0)
    s_barrier
    v_mfma_f32_16x16x32_bf16 v[64:67], v[112:115], v[48:51], v[64:67]
    v_mfma_f32_16x16x32_bf16 v[68:71], v[112:115], v[52:55], v[68:71]
    ds_read_b64_tr_b16 v[96:97], v8 offset:0
    ds_read_b64_tr_b16 v[98:99], v8 offset:2048
    ds_read_b64_tr_b16 v[100:101], v9 offset:0
    ds_read_b64_tr_b16 v[102:103], v9 offset:2048
    v_mfma_f32_16x16x32_bf16 v[72:75], v[116:119], v[48:51], v[72:75]
    v_mfma_f32_16x16x32_bf16 v[76:79], v[116:119], v[52:55], v[76:79]
    ds_read_b64_tr_b16 v[104:105], v57 offset:0
    ds_read_b64_tr_b16 v[106:107], v57 offset:2048
    ds_read_b64_tr_b16 v[108:109], v58 offset:0
    ds_read_b64_tr_b16 v[110:111], v58 offset:2048
    v_mfma_f32_16x16x32_bf16 v[80:83], v[120:123], v[48:51], v[80:83]
    v_mfma_f32_16x16x32_bf16 v[84:87], v[120:123], v[52:55], v[84:87]
    s_add_u32 m0, s35, 49152
    s_add_u32 s24, s34, 1441792
    buffer_load_dwordx4 v7, s[48:51], s24 offen lds
    s_add_u32 m0, s35, 50176
    s_add_u32 s24, s34, 1449984
    buffer_load_dwordx4 v7, s[48:51], s24 offen lds
    v_mfma_f32_16x16x32_bf16 v[88:91], v[124:127], v[48:51], v[88:91]
    v_mfma_f32_16x16x32_bf16 v[92:95], v[124:127], v[52:55], v[92:95]
    s_add_u32 s24, s33, 122880
    buffer_load_dwordx4 v[48:51], v18, s[12:15], s24 offen sc1
    buffer_load_dwordx4 v[52:55], v18, s[12:15], s24 offen offset:1024 sc1
    s_waitcnt vmcnt(10) lgkmcnt(0)
    s_barrier
    v_mfma_f32_16x16x32_bf16 v[64:67], v[96:99], v[24:27], v[64:67]
    v_mfma_f32_16x16x32_bf16 v[68:71], v[96:99], v[28:31], v[68:71]
    ds_read_b64_tr_b16 v[112:113], v8 offset:16384
    ds_read_b64_tr_b16 v[114:115], v8 offset:18432
    ds_read_b64_tr_b16 v[116:117], v9 offset:16384
    ds_read_b64_tr_b16 v[118:119], v9 offset:18432
    v_mfma_f32_16x16x32_bf16 v[72:75], v[100:103], v[24:27], v[72:75]
    v_mfma_f32_16x16x32_bf16 v[76:79], v[100:103], v[28:31], v[76:79]
    ds_read_b64_tr_b16 v[120:121], v57 offset:16384
    ds_read_b64_tr_b16 v[122:123], v57 offset:18432
    ds_read_b64_tr_b16 v[124:125], v58 offset:16384
    ds_read_b64_tr_b16 v[126:127], v58 offset:18432
    v_mfma_f32_16x16x32_bf16 v[80:83], v[104:107], v[24:27], v[80:83]
    v_mfma_f32_16x16x32_bf16 v[84:87], v[104:107], v[28:31], v[84:87]
    s_add_u32 m0, s35, 0
    s_add_u32 s24, s34, 1572864
    buffer_load_dwordx4 v7, s[48:51], s24 offen lds
    s_add_u32 m0, s35, 1024
    s_add_u32 s24, s34, 1581056
    buffer_load_dwordx4 v7, s[48:51], s24 offen lds
    v_mfma_f32_16x16x32_bf16 v[88:91], v[108:111], v[24:27], v[88:91]
    v_mfma_f32_16x16x32_bf16 v[92:95], v[108:111], v[28:31], v[92:95]
    s_add_u32 s24, s33, 131072
    buffer_load_dwordx4 v[24:27], v18, s[12:15], s24 offen sc1
    buffer_load_dwordx4 v[28:31], v18, s[12:15], s24 offen offset:1024 sc1
    s_waitcnt vmcnt(10) lgkmcnt(0)
    s_barrier
    v_mfma_f32_16x16x32_bf16 v[64:67], v[112:115], v[32:35], v[64:67]
    v_mfma_f32_16x16x32_bf16 v[68:71], v[112:115], v[36:39], v[68:71]
    ds_read_b64_tr_b16 v[96:97], v8 offset:32768
    ds_read_b64_tr_b16 v[98:99], v8 offset:34816
    ds_read_b64_tr_b16 v[100:101], v9 offset:32768
    ds_read_b64_tr_b16 v[102:103], v9 offset:34816
    v_mfma_f32_16x16x32_bf16 v[72:75], v[116:119], v[32:35], v[72:75]
    v_mfma_f32_16x16x32_bf16 v[76:79], v[116:119], v[36:39], v[76:79]
    ds_read_b64_tr_b16 v[104:105], v57 offset:32768
    ds_read_b64_tr_b16 v[106:107], v57 offset:34816
    ds_read_b64_tr_b16 v[108:109], v58 offset:32768
    ds_read_b64_tr_b16 v[110:111], v58 offset:34816
    v_mfma_f32_16x16x32_bf16 v[80:83], v[120:123], v[32:35], v[80:83]
    v_mfma_f32_16x16x32_bf16 v[84:87], v[120:123], v[36:39], v[84:87]
    s_add_u32 m0, s35, 16384
    s_add_u32 s24, s34, 1703936
    buffer_load_dwordx4 v7, s[48:51], s24 offen lds
    s_add_u32 m0, s35, 17408
    s_add_u32 s24, s34, 1712128
    buffer_load_dwordx4 v7, s[48:51], s24 offen lds
    v_mfma_f32_16x16x32_bf16 v[88:91], v[124:127], v[32:35], v[88:91]
    v_mfma_f32_16x16x32_bf16 v[92:95], v[124:127], v[36:39], v[92:95]
    s_add_u32 s24, s33, 139264
    buffer_load_dwordx4 v[32:35], v18, s[12:15], s24 offen sc1
    buffer_load_dwordx4 v[36:39], v18, s[12:15], s24 offen offset:1024 sc1
    s_waitcnt vmcnt(10) lgkmcnt(0)
    s_barrier
    v_mfma_f32_16x16x32_bf16 v[64:67], v[96:99], v[40:43], v[64:67]
    v_mfma_f32_16x16x32_bf16 v[68:71], v[96:99], v[44:47], v[68:71]
    ds_read_b64_tr_b16 v[112:113], v8 offset:49152
    ds_read_b64_tr_b16 v[114:115], v8 offset:51200
    ds_read_b64_tr_b16 v[116:117], v9 offset:49152
    ds_read_b64_tr_b16 v[118:119], v9 offset:51200
    v_mfma_f32_16x16x32_bf16 v[72:75], v[100:103], v[40:43], v[72:75]
    v_mfma_f32_16x16x32_bf16 v[76:79], v[100:103], v[44:47], v[76:79]
    ds_read_b64_tr_b16 v[120:121], v57 offset:49152
    ds_read_b64_tr_b16 v[122:123], v57 offset:51200
    ds_read_b64_tr_b16 v[124:125], v58 offset:49152
    ds_read_b64_tr_b16 v[126:127], v58 offset:51200
    v_mfma_f32_16x16x32_bf16 v[80:83], v[104:107], v[40:43], v[80:83]
    v_mfma_f32_16x16x32_bf16 v[84:87], v[104:107], v[44:47], v[84:87]
    s_add_u32 m0, s35, 32768
    s_add_u32 s24, s21, 0
    buffer_load_dwordx4 v7, s[44:47], s24 offen lds
    s_add_u32 m0, s35, 33792
    s_add_u32 s24, s21, 16384
    buffer_load_dwordx4 v7, s[44:47], s24 offen lds
    v_mfma_f32_16x16x32_bf16 v[88:91], v[108:111], v[40:43], v[88:91]
    v_mfma_f32_16x16x32_bf16 v[92:95], v[108:111], v[44:47], v[92:95]
    s_waitcnt vmcnt(8) lgkmcnt(0)
    s_barrier
    v_mfma_f32_16x16x32_bf16 v[64:67], v[112:115], v[48:51], v[64:67]
    v_mfma_f32_16x16x32_bf16 v[68:71], v[112:115], v[52:55], v[68:71]
    ds_read_b64_tr_b16 v[96:97], v8 offset:0
    ds_read_b64_tr_b16 v[98:99], v8 offset:2048
    ds_read_b64_tr_b16 v[100:101], v9 offset:0
    ds_read_b64_tr_b16 v[102:103], v9 offset:2048
    v_mfma_f32_16x16x32_bf16 v[72:75], v[116:119], v[48:51], v[72:75]
    v_mfma_f32_16x16x32_bf16 v[76:79], v[116:119], v[52:55], v[76:79]
    ds_read_b64_tr_b16 v[104:105], v57 offset:0
    ds_read_b64_tr_b16 v[106:107], v57 offset:2048
    ds_read_b64_tr_b16 v[108:109], v58 offset:0
    ds_read_b64_tr_b16 v[110:111], v58 offset:2048
    v_mfma_f32_16x16x32_bf16 v[80:83], v[120:123], v[48:51], v[80:83]
    v_mfma_f32_16x16x32_bf16 v[84:87], v[120:123], v[52:55], v[84:87]
    s_add_u32 m0, s35, 49152
    s_add_u32 s24, s21, 131072
    buffer_load_dwordx4 v7, s[44:47], s24 offen lds
    s_add_u32 m0, s35, 50176
    s_add_u32 s24, s21, 147456
    buffer_load_dwordx4 v7, s[44:47], s24 offen lds
    v_mfma_f32_16x16x32_bf16 v[88:91], v[124:127], v[48:51], v[88:91]
    v_mfma_f32_16x16x32_bf16 v[92:95], v[124:127], v[52:55], v[92:95]
    s_waitcnt vmcnt(6) lgkmcnt(0)
    s_barrier
    v_mfma_f32_16x16x32_bf16 v[64:67], v[96:99], v[24:27], v[64:67]
    v_mfma_f32_16x16x32_bf16 v[68:71], v[96:99], v[28:31], v[68:71]
    ds_read_b64_tr_b16 v[112:113], v8 offset:16384
    ds_read_b64_tr_b16 v[114:115], v8 offset:18432
    ds_read_b64_tr_b16 v[116:117], v9 offset:16384
    ds_read_b64_tr_b16 v[118:119], v9 offset:18432
    v_mfma_f32_16x16x32_bf16 v[72:75], v[100:103], v[24:27], v[72:75]
    v_mfma_f32_16x16x32_bf16 v[76:79], v[100:103], v[28:31], v[76:79]
    ds_read_b64_tr_b16 v[120:121], v57 offset:16384
    ds_read_b64_tr_b16 v[122:123], v57 offset:18432
    ds_read_b64_tr_b16 v[124:125], v58 offset:16384
    ds_read_b64_tr_b16 v[126:127], v58 offset:18432
    v_mfma_f32_16x16x32_bf16 v[80:83], v[104:107], v[24:27], v[80:83]
    v_mfma_f32_16x16x32_bf16 v[84:87], v[104:107], v[28:31], v[84:87]
    s_add_u32 m0, s35, 0
    s_add_u32 s24, s21, 262144
    buffer_load_dwordx4 v7, s[44:47], s24 offen lds
    s_add_u32 m0, s35, 1024
    s_add_u32 s24, s21, 278528
    buffer_load_dwordx4 v7, s[44:47], s24 offen lds
    v_mfma_f32_16x16x32_bf16 v[88:91], v[108:111], v[24:27], v[88:91]
    v_mfma_f32_16x16x32_bf16 v[92:95], v[108:111], v[28:31], v[92:95]
    s_waitcnt vmcnt(4) lgkmcnt(0)
    s_barrier
    v_mfma_f32_16x16x32_bf16 v[64:67], v[112:115], v[32:35], v[64:67]
    v_mfma_f32_16x16x32_bf16 v[68:71], v[112:115], v[36:39], v[68:71]
    ds_read_b64_tr_b16 v[96:97], v8 offset:32768
    ds_read_b64_tr_b16 v[98:99], v8 offset:34816
    ds_read_b64_tr_b16 v[100:101], v9 offset:32768
    ds_read_b64_tr_b16 v[102:103], v9 offset:34816
    v_mfma_f32_16x16x32_bf16 v[72:75], v[116:119], v[32:35], v[72:75]
    v_mfma_f32_16x16x32_bf16 v[76:79], v[116:119], v[36:39], v[76:79]
    ds_read_b64_tr_b16 v[104:105], v57 offset:32768
    ds_read_b64_tr_b16 v[106:107], v57 offset:34816
    ds_read_b64_tr_b16 v[108:109], v58 offset:32768
    ds_read_b64_tr_b16 v[110:111], v58 offset:34816
    v_mfma_f32_16x16x32_bf16 v[80:83], v[120:123], v[32:35], v[80:83]
    v_mfma_f32_16x16x32_bf16 v[84:87], v[120:123], v[36:39], v[84:87]
    s_add_u32 m0, s35, 16384
    s_add_u32 s24, s21, 393216
    buffer_load_dwordx4 v7, s[44:47], s24 offen lds
    s_add_u32 m0, s35, 17408
    s_add_u32 s24, s21, 409600
    buffer_load_dwordx4 v7, s[44:47], s24 offen lds
    v_mfma_f32_16x16x32_bf16 v[88:91], v[124:127], v[32:35], v[88:91]
    v_mfma_f32_16x16x32_bf16 v[92:95], v[124:127], v[36:39], v[92:95]
    s_add_u32 s26, s33, s12
    s_addc_u32 s27, s13, 0
    s_load_dword s86, s[26:27], 1532 glc
    s_load_dword s87, s[26:27], 2044 glc
    s_load_dword s88, s[26:27], 9724 glc
    s_load_dword s89, s[26:27], 10236 glc
    s_load_dword s90, s[26:27], 17916 glc
    s_load_dword s91, s[26:27], 18428 glc
    s_load_dword s92, s[26:27], 26108 glc
    s_load_dword s93, s[26:27], 26620 glc
    s_waitcnt vmcnt(0)
    s_barrier
    ds_read_b64_tr_b16 v[112:113], v8 offset:49152
    ds_read_b64_tr_b16 v[114:115], v8 offset:51200
    ds_read_b64_tr_b16 v[116:117], v9 offset:49152
    ds_read_b64_tr_b16 v[118:119], v9 offset:51200
    ds_read_b64_tr_b16 v[120:121], v57 offset:49152
    ds_read_b64_tr_b16 v[122:123], v57 offset:51200
    ds_read_b64_tr_b16 v[124:125], v58 offset:49152
    ds_read_b64_tr_b16 v[126:127], v58 offset:51200
    s_setprio 3
    s_waitcnt lgkmcnt(0)
    s_barrier
    s_mov_b32 s53, 200000
L_f_lp:
    s_max_u32 s24, s86, s87
    s_max_u32 s24, s24, s88
    s_max_u32 s24, s24, s89
    s_max_u32 s24, s24, s90
    s_max_u32 s24, s24, s91
    s_max_u32 s24, s24, s92
    s_max_u32 s24, s24, s93
    s_cmp_lg_u32 s24, -1
    s_cbranch_scc1 L_f_lpd
    s_sub_u32 s53, s53, 1
    s_cbranch_scc1 L_f_lpd
    s_cmp_eq_u32 s86, -1
    s_cbranch_scc0 L_lk33
    s_load_dword s86, s[26:27], 1532 glc
L_lk33:
    s_cmp_eq_u32 s87, -1
    s_cbranch_scc0 L_lk34
    s_load_dword s87, s[26:27], 2044 glc
L_lk34:
    s_cmp_eq_u32 s88, -1
    s_cbranch_scc0 L_lk35
    s_load_dword s88, s[26:27], 9724 glc
L_lk35:
    s_cmp_eq_u32 s89, -1
    s_cbranch_scc0 L_lk36
    s_load_dword s89, s[26:27], 10236 glc
L_lk36:
    s_cmp_eq_u32 s90, -1
    s_cbranch_scc0 L_lk37
    s_load_dword s90, s[26:27], 17916 glc
L_lk37:
    s_cmp_eq_u32 s91, -1
    s_cbranch_scc0 L_lk38
    s_load_dword s91, s[26:27], 18428 glc
L_lk38:
    s_cmp_eq_u32 s92, -1
    s_cbranch_scc0 L_lk39
    s_load_dword s92, s[26:27], 26108 glc
L_lk39:
    s_cmp_eq_u32 s93, -1
    s_cbranch_scc0 L_lk40
    s_load_dword s93, s[26:27], 26620 glc
L_lk40:
L_f_lw:
    s_waitcnt lgkmcnt(0)
    s_branch L_f_lp
L_f_lpd:
    s_add_u32 s24, s33, 0
    buffer_load_dwordx4 v[24:27], v18, s[12:15], s24 offen sc0 sc1
    s_add_u32 s24, s33, 1024
    buffer_load_dwordx4 v[28:31], v18, s[12:15], s24 offen sc0 sc1
    s_add_u32 s24, s33, 8192
    buffer_load_dwordx4 v[32:35], v18, s[12:15], s24 offen sc0 sc1
    s_add_u32 s24, s33, 9216
    buffer_load_dwordx4 v[36:39], v18, s[12:15], s24 offen sc0 sc1
    s_add_u32 s24, s33, 16384
    buffer_load_dwordx4 v[40:43], v18, s[12:15], s24 offen sc0 sc1
    s_add_u32 s24, s33, 17408
    buffer_load_dwordx4 v[44:47], v18, s[12:15], s24 offen sc0 sc1
    s_add_u32 s24, s33, 24576
    buffer_load_dwordx4 v[48:51], v18, s[12:15], s24 offen sc0 sc1
    s_add_u32 s24, s33, 25600
    buffer_load_dwordx4 v[52:55], v18, s[12:15], s24 offen sc0 sc1
    s_mov_b32 s53, 200000
    s_waitcnt vmcnt(6)
L_f_rt0:
    v_max3_u32 v14, v24, v25, v26
    v_max3_u32 v15, v27, v28, v29
    v_max3_u32 v14, v14, v30, v31
    v_max_u32 v14, v14, v15
    v_cmp_eq_u32 vcc, -1, v14
    s_nop 3
    s_cbranch_vccnz L_f_rl0
L_f_ok0:
    v_mfma_f32_16x16x32_bf16 v[64:67], v[96:99], v[24:27], v[64:67]
    v_mfma_f32_16x16x32_bf16 v[68:71], v[96:99], v[28:31], v[68:71]
    v_mfma_f32_16x16x32_bf16 v[72:75], v[100:103], v[24:27], v[72:75]
    v_mfma_f32_16x16x32_bf16 v[76:79], v[100:103], v[28:31], v[76:79]
    v_mfma_f32_16x16x32_bf16 v[80:83], v[104:107], v[24:27], v[80:83]
    v_mfma_f32_16x16x32_bf16 v[84:87], v[104:107], v[28:31], v[84:87]
    v_mfma_f32_16x16x32_bf16 v[88:91], v[108:111], v[24:27], v[88:91]
    v_mfma_f32_16x16x32_bf16 v[92:95], v[108:111], v[28:31], v[92:95]
    ds_read_b64_tr_b16 v[96:97], v8 offset:0
    ds_read_b64_tr_b16 v[98:99], v8 offset:2048
    ds_read_b64_tr_b16 v[100:101], v9 offset:0
    ds_read_b64_tr_b16 v[102:103], v9 offset:2048
    ds_read_b64_tr_b16 v[104:105], v57 offset:0
    ds_read_b64_tr_b16 v[106:107], v57 offset:2048
    ds_read_b64_tr_b16 v[108:109], v58 offset:0
    ds_read_b64_tr_b16 v[110:111], v58 offset:2048
    s_waitcnt vmcnt(4)
L_f_rt1:
    v_max3_u32 v14, v32, v33, v34
    v_max3_u32 v15, v35, v36, v37
    v_max3_u32 v14, v14, v38, v39
    v_max_u32 v14, v14, v15
    v_cmp_eq_u32 vcc, -1, v14
    s_nop 3
    s_cbranch_vccnz L_f_rl1
L_f_ok1:
    v_mfma_f32_16x16x32_bf16 v[64:67], v[112:115], v[32:35], v[64:67]
    v_mfma_f32_16x16x32_bf16 v[68:71], v[112:115], v[36:39], v[68:71]
    v_mfma_f32_16x16x32_bf16 v[72:75], v[116:119], v[32:35], v[72:75]
    v_mfma_f32_16x16x32_bf16 v[76:79], v[116:119], v[36:39], v[76:79]
    v_mfma_f32_16x16x32_bf16 v[80:83], v[120:123], v[32:35], v[80:83]
    v_mfma_f32_16x16x32_bf16 v[84:87], v[120:123], v[36:39], v[84:87]
    v_mfma_f32_16x16x32_bf16 v[88:91], v[124:127], v[32:35], v[88:91]
    v_mfma_f32_16x16x32_bf16 v[92:95], v[124:127], v[36:39], v[92:95]
    ds_read_b64_tr_b16 v[112:113], v8 offset:16384
    ds_read_b64_tr_b16 v[114:115], v8 offset:18432
    ds_read_b64_tr_b16 v[116:117], v9 offset:16384
    ds_read_b64_tr_b16 v[118:119], v9 offset:18432
    ds_read_b64_tr_b16 v[120:121], v57 offset:16384
    ds_read_b64_tr_b16 v[122:123], v57 offset:18432
    ds_read_b64_tr_b16 v[124:125], v58 offset:16384
    ds_read_b64_tr_b16 v[126:127], v58 offset:18432
    s_waitcnt vmcnt(2)
L_f_rt2:
    v_max3_u32 v14, v40, v41, v42
    v_max3_u32 v15, v43, v44, v45
    v_max3_u32 v14, v14, v46, v47
    v_max_u32 v14, v14, v15
    v_cmp_eq_u32 vcc, -1, v14
    s_waitcnt lgkmcnt(8)
    s_nop 3
    s_cbranch_vccnz L_f_rl2
L_f_ok2:
    v_mfma_f32_16x16x32_bf16 v[64:67], v[96:99], v[40:43], v[64:67]
    v_mfma_f32_16x16x32_bf16 v[68:71], v[96:99], v[44:47], v[68:71]
    v_mfma_f32_16x16x32_bf16 v[72:75], v[100:103], v[40:43], v[72:75]
    v_mfma_f32_16x16x32_bf16 v[76:79], v[100:103], v[44:47], v[76:79]
    v_mfma_f32_16x16x32_bf16 v[80:83], v[104:107], v[40:43], v[80:83]
    v_mfma_f32_16x16x32_bf16 v[84:87], v[104:107], v[44:47], v[84:87]
    v_mfma_f32_16x16x32_bf16 v[88:91], v[108:111], v[40:43], v[88:91]
    v_mfma_f32_16x16x32_bf16 v[92:95], v[108:111], v[44:47], v[92:95]
    s_waitcnt vmcnt(0)
L_f_rt3:
    v_max3_u32 v14, v48, v49, v50
    v_max3_u32 v15, v51, v52, v53
    v_max3_u32 v14, v14, v54, v55
    v_max_u32 v14, v14, v15
    v_cmp_eq_u32 vcc, -1, v14
    s_waitcnt lgkmcnt(0)
    s_nop 3
    s_cbranch_vccnz L_f_rl3
L_f_ok3:
    v_mfma_f32_16x16x32_bf16 v[64:67], v[112:115], v[48:51], v[64:67]
    v_mfma_f32_16x16x32_bf16 v[68:71], v[112:115], v[52:55], v[68:71]
    v_mfma_f32_16x16x32_bf16 v[72:75], v[116:119], v[48:51], v[72:75]
    v_mfma_f32_16x16x32_bf16 v[76:79], v[116:119], v[52:55], v[76:79]
    v_mfma_f32_16x16x32_bf16 v[80:83], v[120:123], v[48:51], v[80:83]
    v_mfma_f32_16x16x32_bf16 v[84:87], v[120:123], v[52:55], v[84:87]
    v_mfma_f32_16x16x32_bf16 v[88:91], v[124:127], v[48:51], v[88:91]
    v_mfma_f32_16x16x32_bf16 v[92:95], v[124:127], v[52:55], v[92:95]
    s_nop 2
    ds_write_b128 v11, v[72:75] offset:0
    ds_write_b128 v11, v[76:79] offset:1024
    ds_write_b128 v11, v[80:83] offset:2048
    ds_write_b128 v11, v[84:87] offset:3072
    ds_write_b128 v11, v[88:91] offset:4096
    ds_write_b128 v11, v[92:95] offset:5120
    s_waitcnt lgkmcnt(0)
    s_barrier
    ds_read_b128 v[32:35], v12 offset:0
    ds_read_b128 v[36:39], v12 offset:1024
    ds_read_b128 v[40:43], v13 offset:2048
    ds_read_b128 v[44:47], v13 offset:3072
    ds_read_b128 v[48:51], v19 offset:4096
    ds_read_b128 v[52:55], v19 offset:5120
    s_waitcnt lgkmcnt(4)
    v_add_f32 v64, v64, v32
    v_add_f32 v65, v65, v33
    v_add_f32 v66, v66, v34
    v_add_f32 v67, v67, v35
    v_add_f32 v68, v68, v36
    v_add_f32 v69, v69, v37
    v_add_f32 v70, v70, v38
    v_add_f32 v71, v71, v39
    s_waitcnt lgkmcnt(2)
    v_add_f32 v64, v64, v40
    v_add_f32 v65, v65, v41
    v_add_f32 v66, v66, v42
    v_add_f32 v67, v67, v43
    v_add_f32 v68, v68, v44
    v_add_f32 v69, v69, v45
    v_add_f32 v70, v70, v46
    v_add_f32 v71, v71, v47
    s_waitcnt lgkmcnt(0)
    v_add_f32 v64, v64, v48
    v_add_f32 v65, v65, v49
    v_add_f32 v66, v66, v50
    v_add_f32 v67, v67, v51
    v_add_f32 v68, v68, v52
    v_add_f32 v69, v69, v53
    v_add_f32 v70, v70, v54
    v_add_f32 v71, v71, v55
    v_cvt_pk_bf16_f32 v20, v64, v65
    v_cvt_pk_bf16_f32 v21, v66, v67
    v_cvt_pk_bf16_f32 v22, v68, v69
    v_cvt_pk_bf16_f32 v23, v70, v71
    s_nop 0
    v_permlane16_swap_b32 v20, v22
    v_permlane16_swap_b32 v21, v23
    ds_write_b128 v60, v[20:23]
    s_waitcnt lgkmcnt(0)
    s_barrier
    ds_read_b128 v[20:23], v61
    s_waitcnt lgkmcnt(0)
    buffer_store_dwordx4 v[20:23], v59, s[36:39], 0 offen sc0 sc1
    s_lshl_b32 s24, s2, 3
    s_add_u32 s24, s24, s16
    s_cmp_lg_u32 s24, 2048
    s_cbranch_scc1 L_f_end
    v_mov_b32 v14, 0
    buffer_store_dword v14, off, s[40:43], 0 sc0 sc1
L_f_end:
    s_endpgm
L_f_rl0:
    s_sub_u32 s53, s53, 1
    s_cmp_lt_i32 s53, 0
    s_cbranch_scc1 L_f_ok0
    s_add_u32 s24, s33, 0
    buffer_load_dwordx4 v[24:27], v18, s[12:15], s24 offen sc0 sc1
    s_add_u32 s24, s33, 1024
    buffer_load_dwordx4 v[28:31], v18, s[12:15], s24 offen sc0 sc1
    s_waitcnt vmcnt(0)
    s_branch L_f_rt0
L_f_rl1:
    s_sub_u32 s53, s53, 1
    s_cmp_lt_i32 s53, 0
    s_cbranch_scc1 L_f_ok1
    s_add_u32 s24, s33, 8192
    buffer_load_dwordx4 v[32:35], v18, s[12:15], s24 offen sc0 sc1
    s_add_u32 s24, s33, 9216
    buffer_load_dwordx4 v[36:39], v18, s[12:15], s24 offen sc0 sc1
    s_waitcnt vmcnt(0)
    s_branch L_f_rt1
L_f_rl2:
    s_sub_u32 s53, s53, 1
    s_cmp_lt_i32 s53, 0
    s_cbranch_scc1 L_f_ok2
    s_add_u32 s24, s33, 16384
    buffer_load_dwordx4 v[40:43], v18, s[12:15], s24 offen sc0 sc1
    s_add_u32 s24, s33, 17408
    buffer_load_dwordx4 v[44:47], v18, s[12:15], s24 offen sc0 sc1
    s_waitcnt vmcnt(0)
    s_branch L_f_rt2
L_f_rl3:
    s_sub_u32 s53, s53, 1
    s_cmp_lt_i32 s53, 0
    s_cbranch_scc1 L_f_ok3
    s_add_u32 s24, s33, 24576
    buffer_load_dwordx4 v[48:51], v18, s[12:15], s24 offen sc0 sc1
    s_add_u32 s24, s33, 25600
    buffer_load_dwordx4 v[52:55], v18, s[12:15], s24 offen sc0 sc1
    s_waitcnt vmcnt(0)
    s_branch L_f_rt3
L_exit:
    s_endpgm
.section .rodata,"a"
.p2align 6
.amdhsa_kernel parallel_sum__mha_block__glu_gated_reglu__prompt_kernel
  .amdhsa_next_free_vgpr 128
  .amdhsa_next_free_sgpr 102
  .amdhsa_accum_offset 128
  .amdhsa_group_segment_fixed_size 0
  .amdhsa_kernarg_size 80
  .amdhsa_user_sgpr_count 2
  .amdhsa_user_sgpr_kernarg_segment_ptr 1
  .amdhsa_system_sgpr_workgroup_id_x 1
.end_amdhsa_kernel
```
